```python
import torch

def _softmax(x, axis=-1):
    return torch.softmax(x, dim=axis)
def _gelu(x):
    return torch.nn.functional.gelu(x, approximate="tanh")
def _silu(x):
    return torch.nn.functional.silu(x)
def _sigmoid(x):
    return torch.sigmoid(x)
def _layernorm(x, axis=-1, eps=1e-5):
    m = x.mean(dim=axis, keepdim=True)
    v = x.var(dim=axis, keepdim=True, unbiased=False)
    return (x - m) / torch.sqrt(v + eps)
def _scatter_add(tgt, idx, src, axis=0):
    return tgt.clone().index_add_(axis, idx, src)
def _segment_sum(src, seg, n):
    out = torch.zeros((n,) + src.shape[1:], dtype=src.dtype)
    return out.index_add_(0, seg, src)
def _pad(x, pw):
    flat = tuple(v for pair in reversed(pw) for v in pair)
    return torch.nn.functional.pad(x, flat)

kernel_name = 'parallel_sum__gqa_block_cached__glu_gated_bilinear__decode'

def setup_inputs():

    _w = (lambda a: (lambda t: t.to(torch.bfloat16) if t.is_floating_point() else t)(torch.as_tensor(a)))
    def _A_setup():
        B, Sq, D = 8, 1, 1024
        Hq, Hkv, Sk, Dh = 32, 4, 4096, 128
        assert Hq % Hkv == 0, (Hq, Hkv)
        return {
            "x": _w((lambda *s: torch.randn(*s, dtype=torch.bfloat16) * 0.05)(B, Sq, D)),
            "k_cache": _w((lambda *s: torch.randn(*s, dtype=torch.bfloat16) * 1.6)(B, Hkv, Sk, Dh)),
            "v_cache": _w((lambda *s: torch.randn(*s, dtype=torch.bfloat16) * 0.8)(B, Hkv, Sk, Dh)),
            "wq": _w((lambda *s: torch.randn(*s, dtype=torch.bfloat16) * 1.6)(D, Hq * Dh) * (D ** -0.5)),
            "wo": _w((lambda *s: torch.randn(*s, dtype=torch.bfloat16) * 0.8)(Hq * Dh, D) * ((Hq * Dh) ** -0.5)),
        }
    _A_in = _A_setup()

    def _B_setup():
        B, S, D, F = 8, 1, 1024, 3584
        return {
            "x": _w((lambda *s: torch.randn(*s, dtype=torch.bfloat16) * 0.05)(B, S, D)),
            "w_gate": _w((lambda *s: torch.randn(*s, dtype=torch.bfloat16) * 0.4)(D, F) * (D ** -0.5)),
            "w_up": _w((lambda *s: torch.randn(*s, dtype=torch.bfloat16) * 0.4)(D, F) * (D ** -0.5)),
            "w_down": _w((lambda *s: torch.randn(*s, dtype=torch.bfloat16) * 0.4)(F, D) * (F ** -0.5)),
        }
    _B_in = _B_setup()

    return {
        "A_x": _A_in["x"],
        "A_k_cache": _A_in["k_cache"],
        "A_v_cache": _A_in["v_cache"],
        "A_wq": _A_in["wq"],
        "A_wo": _A_in["wo"],
        "B_x": _B_in["x"],
        "B_w_gate": _B_in["w_gate"],
        "B_w_up": _B_in["w_up"],
        "B_w_down": _B_in["w_down"],
    }

def reference(A_x, A_k_cache, A_v_cache, A_wq, A_wo, B_x, B_w_gate, B_w_up, B_w_down):
    def _A_ref(x, k_cache, v_cache, wq, wo):
        B, Sq, D = x.shape
        Hq, Dh = 32, 128
        Hkv = k_cache.shape[1]
        rep = Hq // Hkv
        q = (lambda x, *d: x.permute(*d))((x @ wq).reshape(B, Sq, Hq, Dh), 0, 2, 1, 3)
        k = (lambda x, n, axis: torch.repeat_interleave(x, n, dim=axis))(k_cache, rep, axis=1)
        v = (lambda x, n, axis: torch.repeat_interleave(x, n, dim=axis))(v_cache, rep, axis=1)
        scores = torch.einsum("bhqd,bhkd->bhqk", q, k) * (Dh ** -0.5)
        p = _softmax(scores, axis=-1)
        o = torch.einsum("bhqk,bhkd->bhqd", p, v)
        return (lambda x, *d: x.permute(*d))(o, 0, 2, 1, 3).reshape(B, Sq, Hq * Dh) @ wo

    def _B_ref(x, w_gate, w_up, w_down):
        g = torch.einsum("bsd,df->bsf", x, w_gate)
        u = torch.einsum("bsd,df->bsf", x, w_up)
        h = g * u
        return torch.einsum("bsf,fd->bsd", h, w_down)

    x = A_x
    xn = _layernorm(x, axis=-1)
    return x + _A_ref(xn, A_k_cache, A_v_cache, A_wq, A_wo) + _B_ref(xn, B_w_gate, B_w_up, B_w_down)
```

```asm
; @launch grid=(256,1,1) block=(256,1,1) lds=54080
.amdgcn_target "amdgcn-amd-amdhsa--gfx950"
.text
.globl parallel_sum__gqa_block_cached__glu_gated_bilinear__decode_kernel
.p2align 8
.type parallel_sum__gqa_block_cached__glu_gated_bilinear__decode_kernel,@function
parallel_sum__gqa_block_cached__glu_gated_bilinear__decode_kernel:
    s_load_dwordx2 s[4:5], s[0:1], 0
    s_load_dwordx2 s[8:9], s[0:1], 24
    s_cmpk_ge_u32 s2, 256
    s_cbranch_scc1 L_done
    s_getpc_b64 s[98:99]
L_pc:
    v_lshlrev_b32 v1, 7, v0
    v_min_u32 v1, L_end-L_pc-4, v1
    global_load_dword v15, v1, s[98:99]
    s_mov_b32 s7, 0x20000
    s_movk_i32 s6, 0x4000
    s_mov_b32 s11, s7
    s_lshl_b32 s10, 1, 23
    v_and_b32 v1, 31, v0
    v_lshlrev_b32 v1, 4, v1
    v_lshrrev_b32 v8, 5, v0
    v_lshl_add_u32 v1, v8, 11, v1
    v_and_b32 v2, 7, v0
    v_lshlrev_b32 v2, 4, v2
    v_lshrrev_b32 v8, 3, v0
    v_lshl_add_u32 v2, v8, 16, v2
    s_and_b32 s52, s2, 7
    s_lshr_b32 s55, s2, 5
    s_bfe_u32 s57, s2, 0x20003
    s_xor_b32 s58, s55, 3
    s_lshl3_add_u32 s54, s52, s58
    s_lshl_b32 s58, s57, 21
    s_lshl_b32 s59, s54, 7
    s_add_u32 s49, s58, s59
    s_waitcnt lgkmcnt(0)
    buffer_load_dwordx4 v[128:131], v1, s[4:7], 0 offen offset:0
    buffer_load_dwordx4 v[132:135], v1, s[4:7], 0 offen offset:512
    buffer_load_dwordx4 v[136:139], v1, s[4:7], 0 offen offset:1024
    buffer_load_dwordx4 v[140:143], v1, s[4:7], 0 offen offset:1536
    buffer_load_dwordx4 v[32:35], v2, s[8:11], s49 offen nt
    s_add_u32 s49, s49, 8192
    buffer_load_dwordx4 v[36:39], v2, s[8:11], s49 offen nt
    s_add_u32 s49, s49, 8192
    buffer_load_dwordx4 v[40:43], v2, s[8:11], s49 offen nt
    s_add_u32 s49, s49, 8192
    buffer_load_dwordx4 v[44:47], v2, s[8:11], s49 offen nt
    s_add_u32 s49, s49, 8192
    buffer_load_dwordx4 v[48:51], v2, s[8:11], s49 offen nt
    s_add_u32 s49, s49, 8192
    buffer_load_dwordx4 v[52:55], v2, s[8:11], s49 offen nt
    s_load_dwordx2 s[12:13], s[0:1], 48
    s_load_dwordx2 s[40:41], s[0:1], 56
    s_load_dwordx2 s[36:37], s[0:1], 88
    s_load_dwordx2 s[16:17], s[0:1], 8
    s_load_dwordx2 s[20:21], s[0:1], 16
    s_load_dwordx2 s[24:25], s[0:1], 64
    s_load_dwordx2 s[28:29], s[0:1], 32
    s_load_dwordx2 s[32:33], s[0:1], 72
    v_readfirstlane_b32 s3, v0
    s_mov_b32 s15, s7
    s_mov_b32 s19, s7
    s_mov_b32 s23, s7
    s_mov_b32 s27, s7
    s_mov_b32 s31, s7
    s_mov_b32 s35, s7
    s_mov_b32 s39, s7
    s_lshl_b32 s18, 1, 25
    s_lshl_b32 s22, 1, 25
    s_lshl_b32 s30, 1, 23
    s_movk_i32 s34, 0x4000
    s_mov_b32 s38, 0x280080
    s_lshr_b32 s3, s3, 6
    s_lshl3_add_u32 s53, s55, s52
    s_lshr_b32 s58, s2, 6
    s_lshl2_add_u32 s50, s52, s58
    s_bfe_u32 s51, s2, 0x30003
    s_sub_u32 s58, s53, 8
    s_mul_i32 s59, s58, 37
    s_lshr_b32 s59, s59, 8
    s_add_u32 s56, s58, s59
    s_and_b32 s59, s56, 7
    s_cmp_ge_u32 s59, 3
    s_addc_u32 s56, s56, 0
    s_lshl3_add_u32 s59, s58, 4294966907
    s_cmp_ge_u32 s58, 49
    s_cselect_b32 s56, s59, s56
    s_cmp_ge_u32 s2, 32
    s_cselect_b32 s14, 0x700000, 0
    s_cselect_b32 s56, s56, 0
    s_cmpk_lt_u32 s2, 224
    s_cselect_b32 s26, 0x700000, 0
    s_and_b32 s58, s57, 1
    s_mul_i32 s58, s58, 3670016
    s_lshl_b32 s59, s56, 7
    s_add_u32 s65, s58, s59
    s_lshl_b32 s100, s50, 20
    s_bitcmp1_b32 s3, 0
    s_cselect_b32 s58, 0x2000, 0
    s_xor_b32 s100, s100, s58
    s_bitcmp1_b32 s3, 1
    s_cselect_b32 s58, 0x4000, 0
    s_xor_b32 s100, s100, s58
    s_bitcmp1_b32 s2, 3
    s_cselect_b32 s58, 0x8000, 0
    s_xor_b32 s100, s100, s58
    s_bitcmp1_b32 s2, 4
    s_cselect_b32 s58, 0x50000, 0
    s_xor_b32 s100, s100, s58
    s_bitcmp1_b32 s2, 5
    s_cselect_b32 s58, 0xa0000, 0
    s_xor_b32 s100, s100, s58
    s_lshl_b32 s58, s53, 17
    s_lshl_b32 s59, s57, 9
    s_add_u32 s101, s58, s59
    s_mov_b32 s47, 0x05040100
    s_mov_b32 s48, 0x07060302
    s_mov_b32 s62, 0xffff0000
    v_and_b32 v3, 7, v0
    v_lshlrev_b32 v3, 4, v3
    v_bfe_u32 v8, v0, 3, 3
    v_mul_u32_u24 v8, 57344, v8
    v_add_u32 v3, v3, v8
    v_lshrrev_b32 v8, 6, v0
    v_mul_u32_u24 v8, 917504, v8
    v_add_u32 v3, v3, v8
    s_waitcnt lgkmcnt(0)
    s_mov_b32 s58, 0x280000
    s_load_dword s42, s[36:37], 0
    s_load_dword s43, s[36:37], s58
    s_bitcmp1_b32 s57, 1
    s_cselect_b32 s12, s40, s12
    s_cselect_b32 s13, s41, s13
    s_movk_i32 s41, 4096
    s_mov_b32 s0, 0x00010001
    s_mov_b32 s1, 0x00010000
    s_mov_b32 s60, 0
    s_cmp_lg_u32 s2, 8
    s_cbranch_scc1 L_nowarm
    s_mul_i32 s58, s3, 0x900
    s_add_u32 s58, s58, 0x4000
    s_xor_b32 s59, s58, 0x2000
    s_load_dword s94, s[36:37], s58 glc
    s_load_dword s95, s[36:37], s59 glc
L_nowarm:
    v_and_b32 v4, 1, v0
    v_lshlrev_b32 v4, 4, v4
    v_bfe_u32 v8, v0, 1, 3
    v_lshl_add_u32 v4, v8, 8, v4
    v_bfe_u32 v8, v0, 4, 2
    v_lshl_add_u32 v4, v8, 5, v4
    v_and_b32 v5, 15, v0
    v_lshlrev_b32 v5, 4, v5
    v_bfe_u32 v8, v0, 4, 2
    v_lshl_add_u32 v5, v8, 9, v5
    v_and_b32 v6, 7, v0
    v_lshlrev_b32 v6, 4, v6
    v_bfe_u32 v8, v0, 3, 3
    v_lshl_add_u32 v6, v8, 14, v6
    v_lshrrev_b32 v8, 6, v0
    v_lshl_add_u32 v6, v8, 7, v6
    v_and_b32 v7, 7, v0
    v_lshlrev_b32 v7, 4, v7
    v_bfe_u32 v8, v0, 3, 2
    v_lshl_add_u32 v7, v8, 12, v7
    v_bfe_u32 v8, v0, 5, 1
    v_lshl_add_u32 v7, v8, 16, v7
    v_lshrrev_b32 v8, 6, v0
    v_lshl_add_u32 v7, v8, 7, v7
    s_waitcnt vmcnt(6)
    v_lshlrev_b32 v160, 16, v128
    v_and_b32 v161, s62, v128
    v_lshlrev_b32 v162, 16, v129
    v_and_b32 v163, s62, v129
    v_lshlrev_b32 v164, 16, v130
    v_and_b32 v165, s62, v130
    v_lshlrev_b32 v166, 16, v131
    v_and_b32 v167, s62, v131
    v_lshlrev_b32 v168, 16, v132
    v_and_b32 v169, s62, v132
    v_lshlrev_b32 v170, 16, v133
    v_and_b32 v171, s62, v133
    v_lshlrev_b32 v172, 16, v134
    v_and_b32 v173, s62, v134
    v_lshlrev_b32 v174, 16, v135
    v_and_b32 v175, s62, v135
    v_lshlrev_b32 v176, 16, v136
    v_and_b32 v177, s62, v136
    v_lshlrev_b32 v178, 16, v137
    v_and_b32 v179, s62, v137
    v_lshlrev_b32 v180, 16, v138
    v_and_b32 v181, s62, v138
    v_lshlrev_b32 v182, 16, v139
    v_and_b32 v183, s62, v139
    v_lshlrev_b32 v184, 16, v140
    v_and_b32 v185, s62, v140
    v_lshlrev_b32 v186, 16, v141
    v_and_b32 v187, s62, v141
    v_lshlrev_b32 v188, 16, v142
    v_and_b32 v189, s62, v142
    v_lshlrev_b32 v190, 16, v143
    v_and_b32 v191, s62, v143
    v_pk_add_f32 v[8:9], v[160:161], v[162:163]
    v_pk_add_f32 v[10:11], v[164:165], v[166:167]
    v_pk_add_f32 v[8:9], v[8:9], v[168:169]
    v_pk_add_f32 v[10:11], v[10:11], v[170:171]
    v_pk_add_f32 v[8:9], v[8:9], v[172:173]
    v_pk_add_f32 v[10:11], v[10:11], v[174:175]
    v_pk_add_f32 v[8:9], v[8:9], v[176:177]
    v_pk_add_f32 v[10:11], v[10:11], v[178:179]
    v_pk_add_f32 v[8:9], v[8:9], v[180:181]
    v_pk_add_f32 v[10:11], v[10:11], v[182:183]
    v_pk_add_f32 v[8:9], v[8:9], v[184:185]
    v_pk_add_f32 v[10:11], v[10:11], v[186:187]
    v_pk_add_f32 v[8:9], v[8:9], v[188:189]
    v_pk_add_f32 v[10:11], v[10:11], v[190:191]
    v_pk_add_f32 v[8:9], v[8:9], v[10:11]
    v_add_f32 v8, v8, v9
    s_add_u32 s49, s49, 8192
    buffer_load_dwordx4 v[56:59], v2, s[8:11], s49 offen nt
    v_add_f32_dpp v8, v8, v8 row_ror:8 row_mask:0xf bank_mask:0xf
    s_nop 1
    v_add_f32_dpp v8, v8, v8 row_ror:4 row_mask:0xf bank_mask:0xf
    s_nop 1
    v_add_f32_dpp v8, v8, v8 row_ror:2 row_mask:0xf bank_mask:0xf
    s_nop 1
    v_add_f32_dpp v8, v8, v8 row_ror:1 row_mask:0xf bank_mask:0xf
    v_mov_b32 v9, v8
    s_nop 1
    v_permlane16_swap_b32 v8, v9
    v_add_f32 v8, v8, v9
    v_mul_f32 v12, 0xba800000, v8
    v_pk_add_f32 v[128:129], v[160:161], v[12:13] op_sel_hi:[1,0]
    v_pk_add_f32 v[130:131], v[162:163], v[12:13] op_sel_hi:[1,0]
    v_pk_add_f32 v[132:133], v[164:165], v[12:13] op_sel_hi:[1,0]
    v_pk_add_f32 v[134:135], v[166:167], v[12:13] op_sel_hi:[1,0]
    v_pk_add_f32 v[136:137], v[168:169], v[12:13] op_sel_hi:[1,0]
    v_pk_add_f32 v[138:139], v[170:171], v[12:13] op_sel_hi:[1,0]
    v_pk_add_f32 v[140:141], v[172:173], v[12:13] op_sel_hi:[1,0]
    v_pk_add_f32 v[142:143], v[174:175], v[12:13] op_sel_hi:[1,0]
    v_pk_add_f32 v[144:145], v[176:177], v[12:13] op_sel_hi:[1,0]
    v_pk_add_f32 v[146:147], v[178:179], v[12:13] op_sel_hi:[1,0]
    v_pk_add_f32 v[148:149], v[180:181], v[12:13] op_sel_hi:[1,0]
    v_pk_add_f32 v[150:151], v[182:183], v[12:13] op_sel_hi:[1,0]
    v_pk_add_f32 v[152:153], v[184:185], v[12:13] op_sel_hi:[1,0]
    v_pk_add_f32 v[154:155], v[186:187], v[12:13] op_sel_hi:[1,0]
    v_pk_add_f32 v[156:157], v[188:189], v[12:13] op_sel_hi:[1,0]
    v_pk_add_f32 v[158:159], v[190:191], v[12:13] op_sel_hi:[1,0]
    v_pk_mul_f32 v[8:9], v[128:129], v[128:129]
    v_pk_mul_f32 v[10:11], v[130:131], v[130:131]
    v_pk_fma_f32 v[8:9], v[132:133], v[132:133], v[8:9]
    v_pk_fma_f32 v[10:11], v[134:135], v[134:135], v[10:11]
    v_pk_fma_f32 v[8:9], v[136:137], v[136:137], v[8:9]
    v_pk_fma_f32 v[10:11], v[138:139], v[138:139], v[10:11]
    v_pk_fma_f32 v[8:9], v[140:141], v[140:141], v[8:9]
    v_pk_fma_f32 v[10:11], v[142:143], v[142:143], v[10:11]
    v_pk_fma_f32 v[8:9], v[144:145], v[144:145], v[8:9]
    v_pk_fma_f32 v[10:11], v[146:147], v[146:147], v[10:11]
    v_pk_fma_f32 v[8:9], v[148:149], v[148:149], v[8:9]
    v_pk_fma_f32 v[10:11], v[150:151], v[150:151], v[10:11]
    v_pk_fma_f32 v[8:9], v[152:153], v[152:153], v[8:9]
    v_pk_fma_f32 v[10:11], v[154:155], v[154:155], v[10:11]
    v_pk_fma_f32 v[8:9], v[156:157], v[156:157], v[8:9]
    v_pk_fma_f32 v[10:11], v[158:159], v[158:159], v[10:11]
    v_pk_add_f32 v[8:9], v[8:9], v[10:11]
    v_add_f32 v8, v8, v9
    s_add_u32 s49, s49, 8192
    buffer_load_dwordx4 v[60:63], v2, s[8:11], s49 offen nt
    v_add_f32_dpp v8, v8, v8 row_ror:8 row_mask:0xf bank_mask:0xf
    s_nop 1
    v_add_f32_dpp v8, v8, v8 row_ror:4 row_mask:0xf bank_mask:0xf
    s_nop 1
    v_add_f32_dpp v8, v8, v8 row_ror:2 row_mask:0xf bank_mask:0xf
    s_nop 1
    v_add_f32_dpp v8, v8, v8 row_ror:1 row_mask:0xf bank_mask:0xf
    v_mov_b32 v9, v8
    s_nop 1
    v_permlane16_swap_b32 v8, v9
    v_add_f32 v8, v8, v9
    v_mul_f32 v8, 0x3a800000, v8
    v_cvt_pk_bf16_f32 v8, v8, v12
    v_and_b32 v12, s62, v8
    v_lshlrev_b32 v8, 16, v8
    v_add_f32 v8, 0x3727c5ac, v8
    v_cvt_pk_bf16_f32 v8, v8, v8
    v_lshlrev_b32 v8, 16, v8
    v_sqrt_f32 v8, v8
    s_nop 0
    v_cvt_pk_bf16_f32 v8, v8, v8
    v_lshlrev_b32 v8, 16, v8
    v_rcp_f32 v10, v8
    v_pk_add_f32 v[160:161], v[160:161], v[12:13] op_sel_hi:[1,0]
    v_pk_add_f32 v[162:163], v[162:163], v[12:13] op_sel_hi:[1,0]
    v_pk_add_f32 v[164:165], v[164:165], v[12:13] op_sel_hi:[1,0]
    v_pk_add_f32 v[166:167], v[166:167], v[12:13] op_sel_hi:[1,0]
    v_pk_add_f32 v[168:169], v[168:169], v[12:13] op_sel_hi:[1,0]
    v_pk_add_f32 v[170:171], v[170:171], v[12:13] op_sel_hi:[1,0]
    v_pk_add_f32 v[172:173], v[172:173], v[12:13] op_sel_hi:[1,0]
    v_pk_add_f32 v[174:175], v[174:175], v[12:13] op_sel_hi:[1,0]
    v_pk_add_f32 v[176:177], v[176:177], v[12:13] op_sel_hi:[1,0]
    v_pk_add_f32 v[178:179], v[178:179], v[12:13] op_sel_hi:[1,0]
    v_pk_add_f32 v[180:181], v[180:181], v[12:13] op_sel_hi:[1,0]
    v_pk_add_f32 v[182:183], v[182:183], v[12:13] op_sel_hi:[1,0]
    v_pk_add_f32 v[184:185], v[184:185], v[12:13] op_sel_hi:[1,0]
    v_pk_add_f32 v[186:187], v[186:187], v[12:13] op_sel_hi:[1,0]
    v_pk_add_f32 v[188:189], v[188:189], v[12:13] op_sel_hi:[1,0]
    v_pk_add_f32 v[190:191], v[190:191], v[12:13] op_sel_hi:[1,0]
    v_cvt_pk_bf16_f32 v128, v160, v161
    v_cvt_pk_bf16_f32 v129, v162, v163
    v_cvt_pk_bf16_f32 v130, v164, v165
    v_cvt_pk_bf16_f32 v131, v166, v167
    v_cvt_pk_bf16_f32 v132, v168, v169
    v_cvt_pk_bf16_f32 v133, v170, v171
    v_cvt_pk_bf16_f32 v134, v172, v173
    v_cvt_pk_bf16_f32 v135, v174, v175
    v_cvt_pk_bf16_f32 v136, v176, v177
    v_cvt_pk_bf16_f32 v137, v178, v179
    v_cvt_pk_bf16_f32 v138, v180, v181
    v_cvt_pk_bf16_f32 v139, v182, v183
    v_cvt_pk_bf16_f32 v140, v184, v185
    v_cvt_pk_bf16_f32 v141, v186, v187
    v_cvt_pk_bf16_f32 v142, v188, v189
    v_cvt_pk_bf16_f32 v143, v190, v191
    s_mov_b32 s49, s65
    buffer_load_dwordx4 v[64:67], v3, s[12:15], s49 offen nt
    v_lshlrev_b32 v160, 16, v128
    v_and_b32 v161, s62, v128
    v_lshlrev_b32 v162, 16, v129
    v_and_b32 v163, s62, v129
    v_lshlrev_b32 v164, 16, v130
    v_and_b32 v165, s62, v130
    v_lshlrev_b32 v166, 16, v131
    v_and_b32 v167, s62, v131
    v_lshlrev_b32 v168, 16, v132
    v_and_b32 v169, s62, v132
    v_lshlrev_b32 v170, 16, v133
    v_and_b32 v171, s62, v133
    v_lshlrev_b32 v172, 16, v134
    v_and_b32 v173, s62, v134
    v_lshlrev_b32 v174, 16, v135
    v_and_b32 v175, s62, v135
    v_lshlrev_b32 v176, 16, v136
    v_and_b32 v177, s62, v136
    v_lshlrev_b32 v178, 16, v137
    v_and_b32 v179, s62, v137
    v_lshlrev_b32 v180, 16, v138
    v_and_b32 v181, s62, v138
    v_lshlrev_b32 v182, 16, v139
    v_and_b32 v183, s62, v139
    v_lshlrev_b32 v184, 16, v140
    v_and_b32 v185, s62, v140
    v_lshlrev_b32 v186, 16, v141
    v_and_b32 v187, s62, v141
    v_lshlrev_b32 v188, 16, v142
    v_and_b32 v189, s62, v142
    v_lshlrev_b32 v190, 16, v143
    v_and_b32 v191, s62, v143
    v_pk_mul_f32 v[160:161], v[160:161], v[10:11] op_sel_hi:[1,0]
    v_pk_mul_f32 v[162:163], v[162:163], v[10:11] op_sel_hi:[1,0]
    v_pk_mul_f32 v[164:165], v[164:165], v[10:11] op_sel_hi:[1,0]
    v_pk_mul_f32 v[166:167], v[166:167], v[10:11] op_sel_hi:[1,0]
    v_pk_mul_f32 v[168:169], v[168:169], v[10:11] op_sel_hi:[1,0]
    v_pk_mul_f32 v[170:171], v[170:171], v[10:11] op_sel_hi:[1,0]
    v_pk_mul_f32 v[172:173], v[172:173], v[10:11] op_sel_hi:[1,0]
    v_pk_mul_f32 v[174:175], v[174:175], v[10:11] op_sel_hi:[1,0]
    v_pk_mul_f32 v[176:177], v[176:177], v[10:11] op_sel_hi:[1,0]
    v_pk_mul_f32 v[178:179], v[178:179], v[10:11] op_sel_hi:[1,0]
    v_pk_mul_f32 v[180:181], v[180:181], v[10:11] op_sel_hi:[1,0]
    v_pk_mul_f32 v[182:183], v[182:183], v[10:11] op_sel_hi:[1,0]
    v_pk_mul_f32 v[184:185], v[184:185], v[10:11] op_sel_hi:[1,0]
    v_pk_mul_f32 v[186:187], v[186:187], v[10:11] op_sel_hi:[1,0]
    v_pk_mul_f32 v[188:189], v[188:189], v[10:11] op_sel_hi:[1,0]
    v_pk_mul_f32 v[190:191], v[190:191], v[10:11] op_sel_hi:[1,0]
    s_add_u32 s49, s49, 7168
    buffer_load_dwordx4 v[68:71], v3, s[12:15], s49 offen nt
    v_cvt_pk_bf16_f32 v128, v160, v161
    v_cvt_pk_bf16_f32 v129, v162, v163
    v_cvt_pk_bf16_f32 v130, v164, v165
    v_cvt_pk_bf16_f32 v131, v166, v167
    v_cvt_pk_bf16_f32 v132, v168, v169
    v_cvt_pk_bf16_f32 v133, v170, v171
    v_cvt_pk_bf16_f32 v134, v172, v173
    v_cvt_pk_bf16_f32 v135, v174, v175
    v_cvt_pk_bf16_f32 v136, v176, v177
    v_cvt_pk_bf16_f32 v137, v178, v179
    v_cvt_pk_bf16_f32 v138, v180, v181
    v_cvt_pk_bf16_f32 v139, v182, v183
    v_cvt_pk_bf16_f32 v140, v184, v185
    v_cvt_pk_bf16_f32 v141, v186, v187
    v_cvt_pk_bf16_f32 v142, v188, v189
    v_cvt_pk_bf16_f32 v143, v190, v191
    ds_write_b128 v1, v[128:131] offset:0
    ds_write_b128 v1, v[132:135] offset:512
    ds_write_b128 v1, v[136:139] offset:1024
    ds_write_b128 v1, v[140:143] offset:1536
    v_and_b32 v8, 1, v0
    v_lshlrev_b32 v8, 4, v8
    v_bfe_u32 v10, v0, 1, 3
    v_lshl_add_u32 v8, v10, 11, v8
    v_bfe_u32 v10, v0, 4, 2
    v_lshl_add_u32 v8, v10, 5, v8
    s_lshl2_add_u32 s58, s57, s3
    s_lshl_b32 s58, s58, 7
    s_and_b32 s59, s57, 1
    s_lshl2_add_u32 s59, s59, s3
    s_lshl_b32 s59, s59, 8
    v_add_u32 v9, s59, v8
    v_add_u32 v8, s58, v8
    s_add_u32 s49, s49, 7168
    buffer_load_dwordx4 v[72:75], v3, s[12:15], s49 offen nt
    s_waitcnt lgkmcnt(0)
    s_barrier
    ds_read_b128 v[16:19], v8 offset:0
    ds_read_b128 v[20:23], v9 offset:0
    ds_read_b128 v[24:27], v9 offset:128
    s_addk_i32 s42, 0x1111
    s_addk_i32 s43, 0x1111
    s_pack_ll_b32_b16 s42, s42, s43
    s_bfe_u32 s43, s42, 0x40000
    s_bfe_u32 s44, s42, 0x40004
    s_bfe_u32 s45, s42, 0x40010
    s_bfe_u32 s46, s42, 0x40014
    s_mul_i32 s8, s43, 0x8001
    s_and_b32 s8, s8, s0
    s_mul_i32 s9, s44, 0x8001
    s_and_b32 s9, s9, s0
    s_mul_i32 s10, s45, 0x8001
    s_and_b32 s10, s10, s0
    s_mul_i32 s11, s46, 0x8001
    s_and_b32 s11, s11, s0
    s_cmp_eq_u32 s2, 8
    s_cbranch_scc1 L_probe
L_probe_back:
    s_bfe_u32 s59, s54, 0x20004
    s_lshl_b32 s59, s59, 14
    s_add_u32 s58, s59, 0x200000
    s_lshl_b32 s59, s57, 12
    s_add_u32 s58, s58, s59
    s_and_b32 s59, s54, 15
    s_lshl_b32 s59, s59, 8
    s_add_u32 s58, s58, s59
    v_and_b32 v1, 15, v0
    v_lshl_add_u32 v1, v1, 4, s58
    v_bfe_u32 v10, v0, 4, 1
    v_lshl_add_u32 v1, v10, 16, v1
    v_lshrrev_b32 v10, 6, v0
    v_lshl_add_u32 v1, v10, 17, v1
    s_and_b32 s58, s56, 7
    s_cmp_eq_u32 s58, 3
    s_cselect_b64 vcc, -1, 0
    s_add_u32 s49, s49, 7168
    s_waitcnt vmcnt(4)
    buffer_load_dwordx4 v[76:79], v3, s[12:15], s49 offen nt
    s_add_u32 s49, s49, 7168
    s_waitcnt vmcnt(4)
    buffer_load_dwordx4 v[80:83], v3, s[12:15], s49 offen nt
    s_waitcnt lgkmcnt(0)
    v_perm_b32 v224, v36, v32, s47
    v_perm_b32 v225, v44, v40, s47
    v_perm_b32 v226, v52, v48, s47
    v_perm_b32 v227, v60, v56, s47
    v_perm_b32 v228, v36, v32, s48
    v_perm_b32 v229, v44, v40, s48
    v_perm_b32 v230, v52, v48, s48
    v_perm_b32 v231, v60, v56, s48
    v_mfma_f32_16x16x32_bf16 v[192:195], v[16:19], v[224:227], 0
    v_perm_b32 v232, v37, v33, s47
    v_perm_b32 v233, v45, v41, s47
    v_perm_b32 v234, v53, v49, s47
    v_perm_b32 v235, v61, v57, s47
    v_mfma_f32_16x16x32_bf16 v[196:199], v[16:19], v[228:231], 0
    v_perm_b32 v236, v37, v33, s48
    v_perm_b32 v237, v45, v41, s48
    v_perm_b32 v238, v53, v49, s48
    v_perm_b32 v239, v61, v57, s48
    v_mfma_f32_16x16x32_bf16 v[200:203], v[16:19], v[232:235], 0
    s_add_u32 s49, s49, 7168
    buffer_load_dwordx4 v[84:87], v3, s[12:15], s49 offen nt
    v_perm_b32 v224, v38, v34, s47
    v_perm_b32 v225, v46, v42, s47
    v_perm_b32 v226, v54, v50, s47
    v_perm_b32 v227, v62, v58, s47
    v_mfma_f32_16x16x32_bf16 v[204:207], v[16:19], v[236:239], 0
    v_perm_b32 v228, v38, v34, s48
    v_perm_b32 v229, v46, v42, s48
    v_perm_b32 v230, v54, v50, s48
    v_perm_b32 v231, v62, v58, s48
    v_mfma_f32_16x16x32_bf16 v[208:211], v[16:19], v[224:227], 0
    v_perm_b32 v232, v39, v35, s47
    v_perm_b32 v233, v47, v43, s47
    v_perm_b32 v234, v55, v51, s47
    v_perm_b32 v235, v63, v59, s47
    v_mfma_f32_16x16x32_bf16 v[212:215], v[16:19], v[228:231], 0
    v_perm_b32 v236, v39, v35, s48
    v_perm_b32 v237, v47, v43, s48
    v_perm_b32 v238, v55, v51, s48
    v_perm_b32 v239, v63, v59, s48
    v_mfma_f32_16x16x32_bf16 v[216:219], v[16:19], v[232:235], 0
    s_nop 0
    v_mfma_f32_16x16x32_bf16 v[220:223], v[16:19], v[236:239], 0
    v_add_f32_dpp v224, v193, v192 row_ror:8 row_mask:0xf bank_mask:0x3
    v_add_f32_dpp v225, v197, v196 row_ror:8 row_mask:0xf bank_mask:0x3
    v_add_f32_dpp v226, v201, v200 row_ror:8 row_mask:0xf bank_mask:0x3
    v_add_f32_dpp v227, v205, v204 row_ror:8 row_mask:0xf bank_mask:0x3
    v_add_f32_dpp v224, v194, v195 row_ror:8 row_mask:0xf bank_mask:0xc
    v_add_f32_dpp v225, v198, v199 row_ror:8 row_mask:0xf bank_mask:0xc
    v_add_f32_dpp v226, v202, v203 row_ror:8 row_mask:0xf bank_mask:0xc
    v_add_f32_dpp v227, v206, v207 row_ror:8 row_mask:0xf bank_mask:0xc
    v_add_f32_dpp v228, v209, v208 row_ror:8 row_mask:0xf bank_mask:0x3
    v_add_f32_dpp v229, v213, v212 row_ror:8 row_mask:0xf bank_mask:0x3
    v_add_f32_dpp v230, v217, v216 row_ror:8 row_mask:0xf bank_mask:0x3
    v_add_f32_dpp v231, v221, v220 row_ror:8 row_mask:0xf bank_mask:0x3
    v_add_f32_dpp v228, v210, v211 row_ror:8 row_mask:0xf bank_mask:0xc
    v_add_f32_dpp v229, v214, v215 row_ror:8 row_mask:0xf bank_mask:0xc
    v_add_f32_dpp v230, v218, v219 row_ror:8 row_mask:0xf bank_mask:0xc
    v_add_f32_dpp v231, v222, v223 row_ror:8 row_mask:0xf bank_mask:0xc
    v_lshlrev_b32 v8, 5, v0
    ds_write_b128 v8, v[224:227] offset:16384
    ds_write_b128 v8, v[228:231] offset:16400
    v_and_b32 v9, 31, v0
    v_lshlrev_b32 v9, 4, v9
    v_lshrrev_b32 v10, 6, v0
    v_lshl_add_u32 v9, v10, 9, v9
    s_add_u32 s49, s49, 7168
    buffer_load_dwordx4 v[88:91], v3, s[12:15], s49 offen nt
    s_waitcnt lgkmcnt(0)
    s_barrier
    ds_read_b128 v[224:227], v9 offset:16384
    ds_read_b128 v[228:231], v9 offset:18432
    ds_read_b128 v[232:235], v9 offset:20480
    ds_read_b128 v[236:239], v9 offset:22528
    s_waitcnt lgkmcnt(2)
    v_add_f32 v224, v224, v228
    v_add_f32 v225, v225, v229
    v_add_f32 v226, v226, v230
    v_add_f32 v227, v227, v231
    s_waitcnt lgkmcnt(0)
    v_add_f32 v232, v232, v236
    v_add_f32 v233, v233, v237
    v_add_f32 v234, v234, v238
    v_add_f32 v235, v235, v239
    v_add_f32 v224, v224, v232
    v_add_f32 v225, v225, v233
    v_add_f32 v226, v226, v234
    v_add_f32 v227, v227, v235
    v_and_or_b32 v224, v224, -16, s43
    v_and_or_b32 v225, v225, -16, s44
    v_and_or_b32 v226, v226, -16, s45
    v_and_or_b32 v227, v227, -16, s46
    v_mov_b32 v244, v224
    v_mov_b32 v245, v225
    v_mov_b32 v246, v226
    v_mov_b32 v247, v227
    s_cmp_eq_u32 s2, 8
    s_cbranch_scc1 L_par
L_par_back:
    s_add_u32 s49, s49, 7168
    s_waitcnt vmcnt(4)
    buffer_load_dwordx4 v[92:95], v3, s[12:15], s49 offen nt
    s_add_u32 s49, s49, 408576
    buffer_load_dwordx4 v[96:99], v3, s[12:15], s49 offen nt
    s_add_u32 s49, s49, 7168
    s_waitcnt vmcnt(5)
    buffer_load_dwordx4 v[100:103], v3, s[12:15], s49 offen nt
    s_add_u32 s49, s49, 7168
    s_waitcnt vmcnt(5)
    buffer_load_dwordx4 v[104:107], v3, s[12:15], s49 offen nt
    s_add_u32 s49, s49, 7168
    s_waitcnt vmcnt(5)
    buffer_load_dwordx4 v[108:111], v3, s[12:15], s49 offen nt
    s_add_u32 s49, s49, 7168
    s_waitcnt vmcnt(4)
    buffer_load_dwordx4 v[112:115], v3, s[12:15], s49 offen nt
    v_perm_b32 v224, v68, v64, s47
    v_perm_b32 v225, v76, v72, s47
    v_perm_b32 v226, v84, v80, s47
    v_perm_b32 v227, v92, v88, s47
    v_perm_b32 v228, v68, v64, s48
    v_perm_b32 v229, v76, v72, s48
    v_perm_b32 v230, v84, v80, s48
    v_perm_b32 v231, v92, v88, s48
    v_mfma_f32_16x16x32_bf16 v[192:195], v[20:23], v[224:227], 0
    v_perm_b32 v232, v69, v65, s47
    v_perm_b32 v233, v77, v73, s47
    v_perm_b32 v234, v85, v81, s47
    v_perm_b32 v235, v93, v89, s47
    v_mfma_f32_16x16x32_bf16 v[196:199], v[20:23], v[228:231], 0
    v_perm_b32 v236, v69, v65, s48
    v_perm_b32 v237, v77, v73, s48
    v_perm_b32 v238, v85, v81, s48
    v_perm_b32 v239, v93, v89, s48
    v_mfma_f32_16x16x32_bf16 v[200:203], v[20:23], v[232:235], 0
    s_add_u32 s49, s49, 7168
    buffer_load_dwordx4 v[116:119], v3, s[12:15], s49 offen nt
    v_perm_b32 v224, v70, v66, s47
    v_perm_b32 v225, v78, v74, s47
    v_perm_b32 v226, v86, v82, s47
    v_perm_b32 v227, v94, v90, s47
    v_mfma_f32_16x16x32_bf16 v[204:207], v[20:23], v[236:239], 0
    v_perm_b32 v228, v70, v66, s48
    v_perm_b32 v229, v78, v74, s48
    v_perm_b32 v230, v86, v82, s48
    v_perm_b32 v231, v94, v90, s48
    v_mfma_f32_16x16x32_bf16 v[208:211], v[20:23], v[224:227], 0
    v_perm_b32 v232, v71, v67, s47
    v_perm_b32 v233, v79, v75, s47
    v_perm_b32 v234, v87, v83, s47
    v_perm_b32 v235, v95, v91, s47
    v_mfma_f32_16x16x32_bf16 v[212:215], v[20:23], v[228:231], 0
    v_perm_b32 v236, v71, v67, s48
    v_perm_b32 v237, v79, v75, s48
    v_perm_b32 v238, v87, v83, s48
    v_perm_b32 v239, v95, v91, s48
    v_mfma_f32_16x16x32_bf16 v[216:219], v[20:23], v[232:235], 0
    s_nop 0
    v_mfma_f32_16x16x32_bf16 v[220:223], v[20:23], v[236:239], 0
    s_lshl_b32 s59, s56, 12
    s_add_u32 s58, s59, 0x8000
    s_lshl_b32 s59, s57, 10
    s_add_u32 s58, s58, s59
    s_cmp_ge_u32 s2, 32
    s_cselect_b32 s58, s58, 0x40000000
    v_and_b32 v2, 31, v0
    v_lshl_add_u32 v2, v2, 3, s58
    v_lshrrev_b32 v10, 6, v0
    v_lshl_add_u32 v2, v10, 8, v2
    s_add_u32 s49, s49, 7168
    s_waitcnt vmcnt(4)
    buffer_load_dwordx4 v[120:123], v3, s[12:15], s49 offen nt
    s_add_u32 s49, s49, 7168
    s_waitcnt vmcnt(4)
    buffer_load_dwordx4 v[124:127], v3, s[12:15], s49 offen nt
    s_mov_b32 s49, s100
    s_waitcnt vmcnt(3)
    buffer_load_dwordx4 a[0:3], v4, s[16:19], s49 offen nt
    s_mov_b32 exec_hi, 0
    buffer_store_dwordx4 v[244:247], v1, s[36:39], 0 offen sc1
    s_mov_b64 exec, -1
    s_waitcnt vmcnt(4)
    buffer_load_dwordx4 a[4:7], v4, s[16:19], s49 offen offset:128 nt
    s_waitcnt vmcnt(4)
    buffer_load_dwordx4 a[8:11], v4, s[16:19], s49 offen offset:2048 nt
    s_cbranch_vccnz L_wide_1
    s_waitcnt vmcnt(4)
L_wide_1:
    buffer_load_dwordx4 a[12:15], v4, s[16:19], s49 offen offset:2176 nt
    s_add_u32 s49, s49, 4096
    s_cbranch_vccnz L_wide_2
    s_waitcnt vmcnt(4)
L_wide_2:
    buffer_load_dwordx4 a[16:19], v4, s[16:19], s49 offen nt
    s_cbranch_vccnz L_wide_3
    s_waitcnt vmcnt(3)
L_wide_3:
    buffer_load_dwordx4 a[20:23], v4, s[16:19], s49 offen offset:128 nt
    s_cbranch_vccnz L_wide_4
    s_waitcnt vmcnt(3)
L_wide_4:
    buffer_load_dwordx4 a[24:27], v4, s[16:19], s49 offen offset:2048 nt
    s_waitcnt vmcnt(8)
    s_cbranch_vccnz L_wide_5
    s_waitcnt vmcnt(3)
L_wide_5:
    buffer_load_dwordx4 a[28:31], v4, s[16:19], s49 offen offset:2176 nt
    v_perm_b32 v224, v100, v96, s47
    v_perm_b32 v225, v108, v104, s47
    v_perm_b32 v226, v116, v112, s47
    v_perm_b32 v227, v124, v120, s47
    v_perm_b32 v228, v100, v96, s48
    v_perm_b32 v229, v108, v104, s48
    v_perm_b32 v230, v116, v112, s48
    v_perm_b32 v231, v124, v120, s48
    v_mfma_f32_16x16x32_bf16 v[192:195], v[24:27], v[224:227], v[192:195]
    v_perm_b32 v232, v101, v97, s47
    v_perm_b32 v233, v109, v105, s47
    v_perm_b32 v234, v117, v113, s47
    v_perm_b32 v235, v125, v121, s47
    v_mfma_f32_16x16x32_bf16 v[196:199], v[24:27], v[228:231], v[196:199]
    v_perm_b32 v236, v101, v97, s48
    v_perm_b32 v237, v109, v105, s48
    v_perm_b32 v238, v117, v113, s48
    v_perm_b32 v239, v125, v121, s48
    v_mfma_f32_16x16x32_bf16 v[200:203], v[24:27], v[232:235], v[200:203]
    s_xor_b32 s49, s100, 0x40000
    buffer_load_dwordx4 a[32:35], v4, s[16:19], s49 offen nt
    v_perm_b32 v224, v102, v98, s47
    v_perm_b32 v225, v110, v106, s47
    v_perm_b32 v226, v118, v114, s47
    v_perm_b32 v227, v126, v122, s47
    v_mfma_f32_16x16x32_bf16 v[204:207], v[24:27], v[236:239], v[204:207]
    v_perm_b32 v228, v102, v98, s48
    v_perm_b32 v229, v110, v106, s48
    v_perm_b32 v230, v118, v114, s48
    v_perm_b32 v231, v126, v122, s48
    v_mfma_f32_16x16x32_bf16 v[208:211], v[24:27], v[224:227], v[208:211]
    v_perm_b32 v232, v103, v99, s47
    v_perm_b32 v233, v111, v107, s47
    v_perm_b32 v234, v119, v115, s47
    v_perm_b32 v235, v127, v123, s47
    v_mfma_f32_16x16x32_bf16 v[212:215], v[24:27], v[228:231], v[212:215]
    v_perm_b32 v236, v103, v99, s48
    v_perm_b32 v237, v111, v107, s48
    v_perm_b32 v238, v119, v115, s48
    v_perm_b32 v239, v127, v123, s48
    v_mfma_f32_16x16x32_bf16 v[216:219], v[24:27], v[232:235], v[216:219]
    s_nop 0
    v_mfma_f32_16x16x32_bf16 v[220:223], v[24:27], v[236:239], v[220:223]
    v_add_f32_dpp v224, v193, v192 row_ror:8 row_mask:0xf bank_mask:0x3
    v_add_f32_dpp v225, v197, v196 row_ror:8 row_mask:0xf bank_mask:0x3
    v_add_f32_dpp v226, v201, v200 row_ror:8 row_mask:0xf bank_mask:0x3
    v_add_f32_dpp v227, v205, v204 row_ror:8 row_mask:0xf bank_mask:0x3
    v_add_f32_dpp v224, v194, v195 row_ror:8 row_mask:0xf bank_mask:0xc
    v_add_f32_dpp v225, v198, v199 row_ror:8 row_mask:0xf bank_mask:0xc
    v_add_f32_dpp v226, v202, v203 row_ror:8 row_mask:0xf bank_mask:0xc
    v_add_f32_dpp v227, v206, v207 row_ror:8 row_mask:0xf bank_mask:0xc
    v_add_f32_dpp v228, v209, v208 row_ror:8 row_mask:0xf bank_mask:0x3
    v_add_f32_dpp v229, v213, v212 row_ror:8 row_mask:0xf bank_mask:0x3
    v_add_f32_dpp v230, v217, v216 row_ror:8 row_mask:0xf bank_mask:0x3
    v_add_f32_dpp v231, v221, v220 row_ror:8 row_mask:0xf bank_mask:0x3
    v_add_f32_dpp v228, v210, v211 row_ror:8 row_mask:0xf bank_mask:0xc
    v_add_f32_dpp v229, v214, v215 row_ror:8 row_mask:0xf bank_mask:0xc
    v_add_f32_dpp v230, v218, v219 row_ror:8 row_mask:0xf bank_mask:0xc
    v_add_f32_dpp v231, v222, v223 row_ror:8 row_mask:0xf bank_mask:0xc
    v_lshlrev_b32 v8, 5, v0
    ds_write_b128 v8, v[224:227] offset:24576
    ds_write_b128 v8, v[228:231] offset:24592
    v_and_b32 v9, 31, v0
    v_lshlrev_b32 v9, 4, v9
    v_lshrrev_b32 v10, 6, v0
    v_lshl_add_u32 v9, v10, 9, v9
    buffer_load_dwordx4 a[36:39], v4, s[16:19], s49 offen offset:128 nt
    s_waitcnt lgkmcnt(0)
    s_barrier
    ds_read_b128 v[224:227], v9 offset:24576
    ds_read_b128 v[228:231], v9 offset:26624
    ds_read_b128 v[232:235], v9 offset:28672
    ds_read_b128 v[236:239], v9 offset:30720
    s_waitcnt lgkmcnt(2)
    v_add_f32 v224, v224, v228
    v_add_f32 v225, v225, v229
    v_add_f32 v226, v226, v230
    v_add_f32 v227, v227, v231
    s_waitcnt lgkmcnt(0)
    v_add_f32 v232, v232, v236
    v_add_f32 v233, v233, v237
    v_add_f32 v234, v234, v238
    v_add_f32 v235, v235, v239
    v_add_f32 v224, v224, v232
    v_add_f32 v225, v225, v233
    v_add_f32 v226, v226, v234
    v_add_f32 v227, v227, v235
    v_add_u32 v224, s1, v224
    v_add_u32 v225, s1, v225
    v_add_u32 v226, s1, v226
    v_add_u32 v227, s1, v227
    v_perm_b32 v224, v225, v224, s48
    v_perm_b32 v225, v227, v226, s48
    v_mov_b32 v8, s0
    v_mov_b32_dpp v226, v224 quad_perm:[1,1,3,3] row_mask:0xf bank_mask:0xf
    v_mov_b32_dpp v227, v225 quad_perm:[1,1,3,3] row_mask:0xf bank_mask:0xf
    v_bfi_b32 v224, v8, s8, v224
    v_bfi_b32 v225, v8, s9, v225
    v_bfi_b32 v226, v8, s10, v226
    v_bfi_b32 v227, v8, s11, v227
    v_mov_b32 v24, v224
    v_mov_b32 v25, v225
    v_mov_b32 v26, v226
    v_mov_b32 v27, v227
    s_lshl_b32 s59, s50, 14
    s_add_u32 s58, s59, 0x200000
    v_lshl_add_u32 v14, v0, 4, s58
    v_add_u32 v15, 8192, v14
    s_waitcnt vmcnt(7)
    s_cbranch_vccnz L_wide_6
    s_waitcnt vmcnt(6)
L_wide_6:
    buffer_load_dwordx4 a[40:43], v4, s[16:19], s49 offen offset:2048 nt
    s_waitcnt vmcnt(7)
    s_cbranch_vccnz L_wide_7
    s_waitcnt vmcnt(6)
L_wide_7:
    buffer_load_dwordx4 a[44:47], v4, s[16:19], s49 offen offset:2176 nt
    s_add_u32 s49, s49, 4096
    s_waitcnt vmcnt(7)
    s_cbranch_vccnz L_wide_8
    s_waitcnt vmcnt(5)
L_wide_8:
    buffer_load_dwordx4 a[48:51], v4, s[16:19], s49 offen nt
    s_waitcnt vmcnt(7)
    s_cbranch_vccnz L_wide_9
    s_waitcnt vmcnt(5)
L_wide_9:
    buffer_load_dwordx4 a[52:55], v4, s[16:19], s49 offen offset:128 nt
    s_waitcnt vmcnt(7)
    s_cbranch_vccnz L_wide_10
    s_waitcnt vmcnt(5)
L_wide_10:
    buffer_load_dwordx4 a[56:59], v4, s[16:19], s49 offen offset:2048 nt
    s_waitcnt vmcnt(7)
    s_cbranch_vccnz L_wide_11
    s_waitcnt vmcnt(5)
L_wide_11:
    buffer_load_dwordx4 a[60:63], v4, s[16:19], s49 offen offset:2176 nt
    s_xor_b32 s49, s100, 0x80000
    s_waitcnt vmcnt(7)
    s_cbranch_vccnz L_wide_12
    s_waitcnt vmcnt(5)
L_wide_12:
    buffer_load_dwordx4 a[64:67], v4, s[16:19], s49 offen nt
    s_waitcnt vmcnt(7)
    s_cbranch_vccnz L_wide_13
    s_waitcnt vmcnt(5)
L_wide_13:
    buffer_load_dwordx4 a[68:71], v4, s[16:19], s49 offen offset:128 nt
    s_waitcnt vmcnt(7)
    s_cbranch_vccnz L_wide_14
    s_waitcnt vmcnt(5)
L_wide_14:
    buffer_load_dwordx4 a[72:75], v4, s[16:19], s49 offen offset:2048 nt
    s_waitcnt vmcnt(5)
    buffer_load_dwordx4 a[76:79], v4, s[16:19], s49 offen offset:2176 nt
    s_add_u32 s49, s49, 4096
    s_waitcnt vmcnt(5)
    buffer_load_dwordx4 a[80:83], v4, s[16:19], s49 offen nt
    s_waitcnt vmcnt(5)
    buffer_load_dwordx4 a[84:87], v4, s[16:19], s49 offen offset:128 nt
    s_waitcnt vmcnt(5)
    buffer_load_dwordx4 a[88:91], v4, s[16:19], s49 offen offset:2048 nt
    s_waitcnt vmcnt(5)
    buffer_load_dwordx4 a[92:95], v4, s[16:19], s49 offen offset:2176 nt
    s_xor_b32 s49, s100, 0xc0000
    s_waitcnt vmcnt(5)
    buffer_load_dwordx4 a[96:99], v4, s[16:19], s49 offen nt
    s_mov_b32 exec_lo, 0x55555555
    s_mov_b32 exec_hi, 0
    buffer_store_dwordx4 v[24:27], v2, s[36:39], 0 offen sc1
    s_mov_b64 exec, -1
    s_waitcnt vmcnt(6)
    buffer_load_dwordx4 a[100:103], v4, s[16:19], s49 offen offset:128 nt
    s_waitcnt vmcnt(6)
    buffer_load_dwordx4 a[104:107], v4, s[16:19], s49 offen offset:2048 nt
    s_waitcnt vmcnt(6)
    buffer_load_dwordx4 a[108:111], v4, s[16:19], s49 offen offset:2176 nt
    s_add_u32 s49, s49, 4096
    s_waitcnt vmcnt(6)
    buffer_load_dwordx4 a[112:115], v4, s[16:19], s49 offen nt
    s_waitcnt vmcnt(6)
    buffer_load_dwordx4 a[116:119], v4, s[16:19], s49 offen offset:128 nt
    s_waitcnt vmcnt(6)
    buffer_load_dwordx4 a[120:123], v4, s[16:19], s49 offen offset:2048 nt
    s_waitcnt vmcnt(5)
    buffer_load_dwordx4 a[124:127], v4, s[16:19], s49 offen offset:2176 nt
    buffer_load_dwordx4 v[240:243], v14, s[36:39], 0 offen sc1
    buffer_load_dwordx4 v[244:247], v14, s[36:39], s41 offen sc1
    buffer_load_dwordx4 v[248:251], v15, s[36:39], 0 offen sc1
    buffer_load_dwordx4 v[252:255], v15, s[36:39], s41 offen sc1
    s_mov_b32 s49, s100
    s_waitcnt vmcnt(8)
    buffer_load_dwordx4 v[32:35], v5, s[20:23], s49 offen nt
    s_waitcnt vmcnt(8)
    buffer_load_dwordx4 v[36:39], v5, s[20:23], s49 offen offset:256 nt
    s_waitcnt vmcnt(8)
    buffer_load_dwordx4 v[40:43], v5, s[20:23], s49 offen offset:2048 nt
    s_waitcnt vmcnt(8)
    buffer_load_dwordx4 v[44:47], v5, s[20:23], s49 offen offset:2304 nt
    s_add_u32 s49, s49, 4096
    s_waitcnt vmcnt(8)
    buffer_load_dwordx4 v[48:51], v5, s[20:23], s49 offen nt
    s_waitcnt vmcnt(4)
    buffer_load_dwordx4 v[52:55], v5, s[20:23], s49 offen offset:256 nt
L_check_16:
    v_xor_b32 v240, s43, v240
    v_xor_b32 v241, s44, v241
    v_xor_b32 v242, s45, v242
    v_xor_b32 v243, s46, v243
    v_xor_b32 v244, s43, v244
    v_xor_b32 v245, s44, v245
    v_xor_b32 v246, s45, v246
    v_xor_b32 v247, s46, v247
    v_xor_b32 v248, s43, v248
    v_xor_b32 v249, s44, v249
    v_xor_b32 v250, s45, v250
    v_xor_b32 v251, s46, v251
    v_xor_b32 v252, s43, v252
    v_xor_b32 v253, s44, v253
    v_xor_b32 v254, s45, v254
    v_xor_b32 v255, s46, v255
    v_or_b32 v8, v240, v241
    v_or3_b32 v8, v8, v242, v243
    v_or3_b32 v8, v8, v244, v245
    v_or3_b32 v8, v8, v246, v247
    v_or3_b32 v8, v8, v248, v249
    v_or3_b32 v8, v8, v250, v251
    v_or3_b32 v8, v8, v252, v253
    v_or3_b32 v8, v8, v254, v255
    v_and_b32 v8, 15, v8
    v_cmp_ne_u32 vcc, 0, v8
    s_cbranch_vccnz L_retry_15
L_ok_17:
    v_add_f32 v240, v240, v244
    v_add_f32 v248, v248, v252
    v_add_f32 v241, v241, v245
    v_add_f32 v249, v249, v253
    v_add_f32 v242, v242, v246
    v_add_f32 v250, v250, v254
    v_add_f32 v243, v243, v247
    v_add_f32 v251, v251, v255
    v_add_f32 v240, v240, v248
    v_add_f32 v241, v241, v249
    v_add_f32 v242, v242, v250
    v_add_f32 v243, v243, v251
    v_cvt_pk_bf16_f32 v240, v240, v241
    v_cvt_pk_bf16_f32 v241, v242, v243
    v_lshlrev_b32 v8, 3, v0
    ds_write_b64 v8, v[240:241] offset:32768
    v_and_b32 v9, 7, v0
    v_lshlrev_b32 v9, 8, v9
    v_bfe_u32 v10, v0, 3, 1
    v_lshl_add_u32 v9, v10, 4, v9
    v_bfe_u32 v10, v0, 4, 2
    v_lshl_add_u32 v9, v10, 5, v9
    buffer_load_dwordx4 v[56:59], v5, s[20:23], s49 offen offset:2048 nt
    s_waitcnt lgkmcnt(0)
    s_barrier
    ds_read_b128 v[16:19], v9 offset:32768
    ds_read_b128 v[20:23], v9 offset:32896
    s_mov_b32 s63, 0x3db504f3
    s_mov_b32 s64, 0x3fb8aa3b
    s_waitcnt lgkmcnt(0)
    v_mfma_f32_16x16x32_bf16 v[128:131], a[0:3], v[16:19], 0
    v_mfma_f32_16x16x32_bf16 v[128:131], a[4:7], v[20:23], v[128:131]
    v_mfma_f32_16x16x32_bf16 v[132:135], a[8:11], v[16:19], 0
    v_mfma_f32_16x16x32_bf16 v[132:135], a[12:15], v[20:23], v[132:135]
    v_mfma_f32_16x16x32_bf16 v[136:139], a[16:19], v[16:19], 0
    v_mfma_f32_16x16x32_bf16 v[136:139], a[20:23], v[20:23], v[136:139]
    v_mfma_f32_16x16x32_bf16 v[140:143], a[24:27], v[16:19], 0
    v_mfma_f32_16x16x32_bf16 v[140:143], a[28:31], v[20:23], v[140:143]
    v_mfma_f32_16x16x32_bf16 v[144:147], a[32:35], v[16:19], 0
    v_mfma_f32_16x16x32_bf16 v[144:147], a[36:39], v[20:23], v[144:147]
    v_add_f32_dpp v160, v129, v128 row_ror:8 row_mask:0xf bank_mask:0x3
    v_mfma_f32_16x16x32_bf16 v[148:151], a[40:43], v[16:19], 0
    v_mfma_f32_16x16x32_bf16 v[148:151], a[44:47], v[20:23], v[148:151]
    v_add_f32_dpp v161, v133, v132 row_ror:8 row_mask:0xf bank_mask:0x3
    v_add_f32_dpp v160, v130, v131 row_ror:8 row_mask:0xf bank_mask:0xc
    v_mfma_f32_16x16x32_bf16 v[152:155], a[48:51], v[16:19], 0
    v_mfma_f32_16x16x32_bf16 v[152:155], a[52:55], v[20:23], v[152:155]
    v_add_f32_dpp v162, v137, v136 row_ror:8 row_mask:0xf bank_mask:0x3
    v_add_f32_dpp v161, v134, v135 row_ror:8 row_mask:0xf bank_mask:0xc
    v_cvt_pk_bf16_f32 v8, v160, v161
    v_lshlrev_b32 v160, 16, v8
    v_and_b32 v161, s62, v8
    v_mul_f32 v160, s63, v160
    v_mul_f32 v161, s63, v161
    v_cvt_pk_bf16_f32 v8, v160, v161
    v_lshlrev_b32 v160, 16, v8
    v_and_b32 v161, s62, v8
    buffer_load_dwordx4 v[60:63], v5, s[20:23], s49 offen offset:2304 nt
    v_mfma_f32_16x16x32_bf16 v[156:159], a[56:59], v[16:19], 0
    v_mfma_f32_16x16x32_bf16 v[156:159], a[60:63], v[20:23], v[156:159]
    v_add_f32_dpp v163, v141, v140 row_ror:8 row_mask:0xf bank_mask:0x3
    v_add_f32_dpp v162, v138, v139 row_ror:8 row_mask:0xf bank_mask:0xc
    v_mfma_f32_16x16x32_bf16 v[192:195], a[64:67], v[16:19], 0
    v_mfma_f32_16x16x32_bf16 v[192:195], a[68:71], v[20:23], v[192:195]
    v_add_f32_dpp v164, v145, v144 row_ror:8 row_mask:0xf bank_mask:0x3
    v_add_f32_dpp v163, v142, v143 row_ror:8 row_mask:0xf bank_mask:0xc
    v_cvt_pk_bf16_f32 v8, v162, v163
    v_lshlrev_b32 v162, 16, v8
    v_and_b32 v163, s62, v8
    v_mul_f32 v162, s63, v162
    v_mul_f32 v163, s63, v163
    v_cvt_pk_bf16_f32 v8, v162, v163
    v_lshlrev_b32 v162, 16, v8
    v_and_b32 v163, s62, v8
    v_mfma_f32_16x16x32_bf16 v[196:199], a[72:75], v[16:19], 0
    v_mfma_f32_16x16x32_bf16 v[196:199], a[76:79], v[20:23], v[196:199]
    v_add_f32_dpp v165, v149, v148 row_ror:8 row_mask:0xf bank_mask:0x3
    v_add_f32_dpp v164, v146, v147 row_ror:8 row_mask:0xf bank_mask:0xc
    v_mfma_f32_16x16x32_bf16 v[200:203], a[80:83], v[16:19], 0
    v_mfma_f32_16x16x32_bf16 v[200:203], a[84:87], v[20:23], v[200:203]
    v_add_f32_dpp v166, v153, v152 row_ror:8 row_mask:0xf bank_mask:0x3
    v_add_f32_dpp v165, v150, v151 row_ror:8 row_mask:0xf bank_mask:0xc
    v_cvt_pk_bf16_f32 v8, v164, v165
    v_lshlrev_b32 v164, 16, v8
    v_and_b32 v165, s62, v8
    v_mul_f32 v164, s63, v164
    v_mul_f32 v165, s63, v165
    v_cvt_pk_bf16_f32 v8, v164, v165
    v_lshlrev_b32 v164, 16, v8
    v_and_b32 v165, s62, v8
    v_mfma_f32_16x16x32_bf16 v[204:207], a[88:91], v[16:19], 0
    v_mfma_f32_16x16x32_bf16 v[204:207], a[92:95], v[20:23], v[204:207]
    v_add_f32_dpp v167, v157, v156 row_ror:8 row_mask:0xf bank_mask:0x3
    v_add_f32_dpp v166, v154, v155 row_ror:8 row_mask:0xf bank_mask:0xc
    v_mfma_f32_16x16x32_bf16 v[208:211], a[96:99], v[16:19], 0
    v_mfma_f32_16x16x32_bf16 v[208:211], a[100:103], v[20:23], v[208:211]
    v_add_f32_dpp v168, v193, v192 row_ror:8 row_mask:0xf bank_mask:0x3
    v_add_f32_dpp v167, v158, v159 row_ror:8 row_mask:0xf bank_mask:0xc
    v_cvt_pk_bf16_f32 v8, v166, v167
    v_lshlrev_b32 v166, 16, v8
    v_and_b32 v167, s62, v8
    v_mul_f32 v166, s63, v166
    v_mul_f32 v167, s63, v167
    v_cvt_pk_bf16_f32 v8, v166, v167
    v_lshlrev_b32 v166, 16, v8
    v_and_b32 v167, s62, v8
    v_mfma_f32_16x16x32_bf16 v[212:215], a[104:107], v[16:19], 0
    v_mfma_f32_16x16x32_bf16 v[212:215], a[108:111], v[20:23], v[212:215]
    v_add_f32_dpp v169, v197, v196 row_ror:8 row_mask:0xf bank_mask:0x3
    v_add_f32_dpp v168, v194, v195 row_ror:8 row_mask:0xf bank_mask:0xc
    s_xor_b32 s49, s100, 0x40000
    buffer_load_dwordx4 v[64:67], v5, s[20:23], s49 offen nt
    v_mfma_f32_16x16x32_bf16 v[216:219], a[112:115], v[16:19], 0
    v_mfma_f32_16x16x32_bf16 v[216:219], a[116:119], v[20:23], v[216:219]
    v_add_f32_dpp v170, v201, v200 row_ror:8 row_mask:0xf bank_mask:0x3
    v_add_f32_dpp v169, v198, v199 row_ror:8 row_mask:0xf bank_mask:0xc
    v_cvt_pk_bf16_f32 v8, v168, v169
    v_lshlrev_b32 v168, 16, v8
    v_and_b32 v169, s62, v8
    v_mul_f32 v168, s63, v168
    v_mul_f32 v169, s63, v169
    v_cvt_pk_bf16_f32 v8, v168, v169
    v_lshlrev_b32 v168, 16, v8
    v_and_b32 v169, s62, v8
    v_mfma_f32_16x16x32_bf16 v[220:223], a[120:123], v[16:19], 0
    v_mfma_f32_16x16x32_bf16 v[220:223], a[124:127], v[20:23], v[220:223]
    v_add_f32_dpp v171, v205, v204 row_ror:8 row_mask:0xf bank_mask:0x3
    v_add_f32_dpp v170, v202, v203 row_ror:8 row_mask:0xf bank_mask:0xc
    v_add_f32_dpp v172, v209, v208 row_ror:8 row_mask:0xf bank_mask:0x3
    v_add_f32_dpp v171, v206, v207 row_ror:8 row_mask:0xf bank_mask:0xc
    v_cvt_pk_bf16_f32 v8, v170, v171
    v_lshlrev_b32 v170, 16, v8
    v_and_b32 v171, s62, v8
    v_mul_f32 v170, s63, v170
    v_mul_f32 v171, s63, v171
    v_cvt_pk_bf16_f32 v8, v170, v171
    v_lshlrev_b32 v170, 16, v8
    v_and_b32 v171, s62, v8
    v_add_f32_dpp v173, v213, v212 row_ror:8 row_mask:0xf bank_mask:0x3
    v_add_f32_dpp v172, v210, v211 row_ror:8 row_mask:0xf bank_mask:0xc
    v_add_f32_dpp v174, v217, v216 row_ror:8 row_mask:0xf bank_mask:0x3
    v_add_f32_dpp v173, v214, v215 row_ror:8 row_mask:0xf bank_mask:0xc
    v_cvt_pk_bf16_f32 v8, v172, v173
    v_lshlrev_b32 v172, 16, v8
    v_and_b32 v173, s62, v8
    v_mul_f32 v172, s63, v172
    v_mul_f32 v173, s63, v173
    v_cvt_pk_bf16_f32 v8, v172, v173
    v_lshlrev_b32 v172, 16, v8
    v_and_b32 v173, s62, v8
    v_add_f32_dpp v175, v221, v220 row_ror:8 row_mask:0xf bank_mask:0x3
    v_add_f32_dpp v174, v218, v219 row_ror:8 row_mask:0xf bank_mask:0xc
    s_nop 0
    v_add_f32_dpp v175, v222, v223 row_ror:8 row_mask:0xf bank_mask:0xc
    v_cvt_pk_bf16_f32 v8, v174, v175
    v_lshlrev_b32 v174, 16, v8
    v_and_b32 v175, s62, v8
    v_mul_f32 v174, s63, v174
    v_mul_f32 v175, s63, v175
    v_cvt_pk_bf16_f32 v8, v174, v175
    v_lshlrev_b32 v174, 16, v8
    v_and_b32 v175, s62, v8
    v_max3_f32 v10, v160, v161, v162
    v_max3_f32 v10, v10, v163, v164
    v_max3_f32 v10, v10, v165, v166
    v_max3_f32 v10, v10, v167, v168
    v_max3_f32 v10, v10, v169, v170
    v_max3_f32 v10, v10, v171, v172
    v_max3_f32 v10, v10, v173, v174
    v_max_f32 v10, v10, v175
    buffer_load_dwordx4 v[68:71], v5, s[20:23], s49 offen offset:256 nt
    s_nop 0
    v_max_f32_dpp v10, v10, v10 row_ror:8 row_mask:0xf bank_mask:0xf
    v_mov_b32 v11, v10
    s_nop 1
    v_permlane16_swap_b32 v10, v11
    v_max_f32 v10, v10, v11
    v_mov_b32 v11, v10
    s_nop 1
    v_permlane32_swap_b32 v10, v11
    v_max_f32 v10, v10, v11
    v_and_b32 v12, 7, v0
    v_lshlrev_b32 v12, 4, v12
    v_lshl_add_u32 v13, s3, 2, v12
    ds_write_b32 v13, v10 offset:34816
    s_waitcnt lgkmcnt(0)
    s_barrier
    ds_read_b128 v[224:227], v12 offset:34816
    buffer_load_dwordx4 v[72:75], v5, s[20:23], s49 offen offset:2048 nt
    s_waitcnt lgkmcnt(0)
    v_max3_f32 v10, v224, v225, v226
    v_max_f32 v10, v10, v227
    v_pk_add_f32 v[160:161], v[160:161], v[10:11] op_sel_hi:[1,0] neg_lo:[0,1] neg_hi:[0,1]
    v_pk_add_f32 v[162:163], v[162:163], v[10:11] op_sel_hi:[1,0] neg_lo:[0,1] neg_hi:[0,1]
    v_pk_add_f32 v[164:165], v[164:165], v[10:11] op_sel_hi:[1,0] neg_lo:[0,1] neg_hi:[0,1]
    v_pk_add_f32 v[166:167], v[166:167], v[10:11] op_sel_hi:[1,0] neg_lo:[0,1] neg_hi:[0,1]
    v_pk_add_f32 v[168:169], v[168:169], v[10:11] op_sel_hi:[1,0] neg_lo:[0,1] neg_hi:[0,1]
    v_pk_add_f32 v[170:171], v[170:171], v[10:11] op_sel_hi:[1,0] neg_lo:[0,1] neg_hi:[0,1]
    v_pk_add_f32 v[172:173], v[172:173], v[10:11] op_sel_hi:[1,0] neg_lo:[0,1] neg_hi:[0,1]
    v_pk_add_f32 v[174:175], v[174:175], v[10:11] op_sel_hi:[1,0] neg_lo:[0,1] neg_hi:[0,1]
    v_pk_mul_f32 v[160:161], v[160:161], s[64:65] op_sel_hi:[1,0]
    v_pk_mul_f32 v[162:163], v[162:163], s[64:65] op_sel_hi:[1,0]
    v_pk_mul_f32 v[164:165], v[164:165], s[64:65] op_sel_hi:[1,0]
    v_pk_mul_f32 v[166:167], v[166:167], s[64:65] op_sel_hi:[1,0]
    v_pk_mul_f32 v[168:169], v[168:169], s[64:65] op_sel_hi:[1,0]
    v_pk_mul_f32 v[170:171], v[170:171], s[64:65] op_sel_hi:[1,0]
    v_pk_mul_f32 v[172:173], v[172:173], s[64:65] op_sel_hi:[1,0]
    v_pk_mul_f32 v[174:175], v[174:175], s[64:65] op_sel_hi:[1,0]
    v_exp_f32 v160, v160
    v_exp_f32 v161, v161
    v_exp_f32 v162, v162
    v_exp_f32 v163, v163
    v_exp_f32 v164, v164
    v_exp_f32 v165, v165
    v_exp_f32 v166, v166
    v_exp_f32 v167, v167
    v_exp_f32 v168, v168
    v_exp_f32 v169, v169
    v_exp_f32 v170, v170
    v_exp_f32 v171, v171
    v_exp_f32 v172, v172
    v_exp_f32 v173, v173
    v_exp_f32 v174, v174
    v_exp_f32 v175, v175
    buffer_load_dwordx4 v[76:79], v5, s[20:23], s49 offen offset:2304 nt
    v_add_f32 v8, v160, v161
    v_add_f32 v9, v162, v163
    v_add_f32 v8, v8, v164
    v_add_f32 v9, v9, v165
    v_add_f32 v8, v8, v166
    v_add_f32 v9, v9, v167
    v_add_f32 v8, v8, v168
    v_add_f32 v9, v9, v169
    v_add_f32 v8, v8, v170
    v_add_f32 v9, v9, v171
    v_add_f32 v8, v8, v172
    v_add_f32 v9, v9, v173
    v_add_f32 v8, v8, v174
    v_add_f32 v9, v9, v175
    v_add_f32 v8, v8, v9
    s_nop 1
    v_add_f32_dpp v8, v8, v8 row_ror:8 row_mask:0xf bank_mask:0xf
    v_mov_b32 v11, v8
    s_nop 1
    v_permlane16_swap_b32 v8, v11
    v_add_f32 v8, v8, v11
    v_mov_b32 v11, v8
    s_nop 1
    v_permlane32_swap_b32 v8, v11
    v_add_f32 v8, v8, v11
    ds_write_b32 v13, v8 offset:34944
    v_mov_b32_dpp v176, v160 row_ror:8 row_mask:0xf bank_mask:0xf
    v_mov_b32_dpp v177, v161 row_ror:8 row_mask:0xf bank_mask:0xf
    v_mov_b32_dpp v178, v162 row_ror:8 row_mask:0xf bank_mask:0xf
    v_mov_b32_dpp v179, v163 row_ror:8 row_mask:0xf bank_mask:0xf
    v_mov_b32_dpp v180, v164 row_ror:8 row_mask:0xf bank_mask:0xf
    v_mov_b32_dpp v181, v165 row_ror:8 row_mask:0xf bank_mask:0xf
    v_mov_b32_dpp v182, v166 row_ror:8 row_mask:0xf bank_mask:0xf
    v_mov_b32_dpp v183, v167 row_ror:8 row_mask:0xf bank_mask:0xf
    v_mov_b32_dpp v184, v168 row_ror:8 row_mask:0xf bank_mask:0xf
    v_mov_b32_dpp v185, v169 row_ror:8 row_mask:0xf bank_mask:0xf
    v_mov_b32_dpp v186, v170 row_ror:8 row_mask:0xf bank_mask:0xf
    v_mov_b32_dpp v187, v171 row_ror:8 row_mask:0xf bank_mask:0xf
    v_mov_b32_dpp v188, v172 row_ror:8 row_mask:0xf bank_mask:0xf
    v_mov_b32_dpp v189, v173 row_ror:8 row_mask:0xf bank_mask:0xf
    v_mov_b32_dpp v190, v174 row_ror:8 row_mask:0xf bank_mask:0xf
    v_mov_b32_dpp v191, v175 row_ror:8 row_mask:0xf bank_mask:0xf
    s_add_u32 s49, s49, 4096
    buffer_load_dwordx4 v[80:83], v5, s[20:23], s49 offen nt
    v_cvt_pk_bf16_f32 v176, v160, v176
    v_cvt_pk_bf16_f32 v177, v161, v177
    v_cvt_pk_bf16_f32 v178, v162, v178
    v_cvt_pk_bf16_f32 v179, v163, v179
    v_cvt_pk_bf16_f32 v180, v164, v180
    v_cvt_pk_bf16_f32 v181, v165, v181
    v_cvt_pk_bf16_f32 v182, v166, v182
    v_cvt_pk_bf16_f32 v183, v167, v183
    v_cvt_pk_bf16_f32 v184, v168, v184
    v_cvt_pk_bf16_f32 v185, v169, v185
    v_cvt_pk_bf16_f32 v186, v170, v186
    v_cvt_pk_bf16_f32 v187, v171, v187
    v_cvt_pk_bf16_f32 v188, v172, v188
    v_cvt_pk_bf16_f32 v189, v173, v189
    v_cvt_pk_bf16_f32 v190, v174, v190
    v_cvt_pk_bf16_f32 v191, v175, v191
    s_lshl_b32 s59, s50, 10
    s_add_u32 s58, s59, 0x40000
    s_lshl_b32 s59, s51, 7
    s_add_u32 s58, s58, s59
    s_cmp_eq_u32 s3, 0
    s_cselect_b32 s58, s58, 0x40000000
    v_add_u32 v14, s58, v12
    s_waitcnt lgkmcnt(0)
    s_barrier
    ds_read_b128 v[224:227], v12 offset:34944
    s_mov_b64 exec, 0xff
    s_waitcnt lgkmcnt(0)
    v_add_f32 v224, v224, v225
    v_add_f32 v226, v226, v227
    v_add_f32 v225, v224, v226
    v_mov_b32 v224, v10
    v_mov_b32 v226, s42
    v_mov_b32 v227, s42
    v_and_or_b32 v224, v224, -16, s43
    v_and_or_b32 v225, v225, -16, s44
    v_and_or_b32 v226, v226, -16, s45
    v_and_or_b32 v227, v227, -16, s46
    buffer_store_dwordx4 v[224:227], v14, s[36:39], 0 offen sc1
    s_mov_b64 exec, -1
    s_lshl_b32 s59, s53, 12
    s_add_u32 s58, s59, 0x8000
    s_cmpk_lt_u32 s2, 224
    s_cselect_b32 s58, s58, 0x40000000
    v_and_b32 v14, 15, v0
    v_lshl_add_u32 v14, v14, 4, s58
    v_bfe_u32 v8, v0, 4, 2
    v_lshl_add_u32 v14, v8, 10, v14
    v_lshrrev_b32 v8, 6, v0
    v_lshl_add_u32 v14, v8, 8, v14
    buffer_load_dwordx4 v[16:19], v14, s[36:39], 0 offen sc1
    v_mov_b32 v175, 0
    buffer_load_dword v174, v175, s[36:39], 0 offen offset:128 sc1
    s_waitcnt vmcnt(8)
    buffer_load_dwordx4 v[84:87], v5, s[20:23], s49 offen offset:256 nt
    v_perm_b32 v224, v36, v32, s47
    v_perm_b32 v225, v44, v40, s47
    v_perm_b32 v226, v52, v48, s47
    v_perm_b32 v227, v60, v56, s47
    v_perm_b32 v228, v36, v32, s48
    v_perm_b32 v229, v44, v40, s48
    v_perm_b32 v230, v52, v48, s48
    v_perm_b32 v231, v60, v56, s48
    v_mfma_f32_16x16x32_bf16 v[192:195], v[224:227], v[176:179], 0
    v_perm_b32 v232, v37, v33, s47
    v_perm_b32 v233, v45, v41, s47
    v_perm_b32 v234, v53, v49, s47
    v_perm_b32 v235, v61, v57, s47
    v_mfma_f32_16x16x32_bf16 v[196:199], v[228:231], v[176:179], 0
    v_perm_b32 v236, v37, v33, s48
    v_perm_b32 v237, v45, v41, s48
    v_perm_b32 v238, v53, v49, s48
    v_perm_b32 v239, v61, v57, s48
    v_mfma_f32_16x16x32_bf16 v[200:203], v[232:235], v[176:179], 0
    buffer_load_dwordx4 v[88:91], v5, s[20:23], s49 offen offset:2048 nt
    v_perm_b32 v224, v38, v34, s47
    v_perm_b32 v225, v46, v42, s47
    v_perm_b32 v226, v54, v50, s47
    v_perm_b32 v227, v62, v58, s47
    v_mfma_f32_16x16x32_bf16 v[204:207], v[236:239], v[176:179], 0
    v_perm_b32 v228, v38, v34, s48
    v_perm_b32 v229, v46, v42, s48
    v_perm_b32 v230, v54, v50, s48
    v_perm_b32 v231, v62, v58, s48
    v_mfma_f32_16x16x32_bf16 v[208:211], v[224:227], v[176:179], 0
    v_perm_b32 v232, v39, v35, s47
    v_perm_b32 v233, v47, v43, s47
    v_perm_b32 v234, v55, v51, s47
    v_perm_b32 v235, v63, v59, s47
    v_mfma_f32_16x16x32_bf16 v[212:215], v[228:231], v[176:179], 0
    v_perm_b32 v236, v39, v35, s48
    v_perm_b32 v237, v47, v43, s48
    v_perm_b32 v238, v55, v51, s48
    v_perm_b32 v239, v63, v59, s48
    v_mfma_f32_16x16x32_bf16 v[216:219], v[232:235], v[176:179], 0
    s_nop 0
    v_mfma_f32_16x16x32_bf16 v[220:223], v[236:239], v[176:179], 0
    v_mov_b32 v160, s0
    v_and_b32 v8, 1, v0
    v_lshlrev_b32 v8, 4, v8
    v_mov_b32 v9, 0x3f80
    v_lshlrev_b32 v8, v8, v9
    v_bfe_u32 v9, v0, 1, 2
    v_cmp_eq_u32 vcc, 0, v9
    s_nop 1
    v_cndmask_b32 v28, 0, v8, vcc
    v_cmp_eq_u32 vcc, 1, v9
    s_nop 1
    v_cndmask_b32 v29, 0, v8, vcc
    v_cmp_eq_u32 vcc, 2, v9
    s_nop 1
    v_cndmask_b32 v30, 0, v8, vcc
    v_cmp_eq_u32 vcc, 3, v9
    s_nop 1
    v_cndmask_b32 v31, 0, v8, vcc
    s_mov_b32 vcc_lo, 0x00ff00ff
    s_mov_b32 vcc_hi, 0xff00ff00
    v_cndmask_b32 v176, 0, v28, vcc
    v_cndmask_b32 v177, 0, v29, vcc
    v_cndmask_b32 v178, 0, v30, vcc
    v_cndmask_b32 v179, 0, v31, vcc
    s_waitcnt vmcnt(8)
    buffer_load_dwordx4 v[92:95], v5, s[20:23], s49 offen offset:2304 nt
    s_xor_b32 s49, s100, 0x80000
    buffer_load_dwordx4 v[96:99], v5, s[20:23], s49 offen nt
    s_waitcnt vmcnt(9)
    buffer_load_dwordx4 v[100:103], v5, s[20:23], s49 offen offset:256 nt
    s_waitcnt vmcnt(9)
    buffer_load_dwordx4 v[104:107], v5, s[20:23], s49 offen offset:2048 nt
    s_waitcnt vmcnt(9)
    buffer_load_dwordx4 v[108:111], v5, s[20:23], s49 offen offset:2304 nt
    s_add_u32 s49, s49, 4096
    s_waitcnt vmcnt(6)
    buffer_load_dwordx4 v[112:115], v5, s[20:23], s49 offen nt
    s_waitcnt vmcnt(6)
    buffer_load_dwordx4 v[116:119], v5, s[20:23], s49 offen offset:256 nt
    s_waitcnt vmcnt(6)
    buffer_load_dwordx4 v[120:123], v5, s[20:23], s49 offen offset:2048 nt
    v_perm_b32 v224, v68, v64, s47
    v_perm_b32 v225, v76, v72, s47
    v_perm_b32 v226, v84, v80, s47
    v_perm_b32 v227, v92, v88, s47
    v_perm_b32 v228, v68, v64, s48
    v_perm_b32 v229, v76, v72, s48
    v_perm_b32 v230, v84, v80, s48
    v_perm_b32 v231, v92, v88, s48
    v_mfma_f32_16x16x32_bf16 v[192:195], v[224:227], v[180:183], v[192:195]
    v_perm_b32 v232, v69, v65, s47
    v_perm_b32 v233, v77, v73, s47
    v_perm_b32 v234, v85, v81, s47
    v_perm_b32 v235, v93, v89, s47
    v_mfma_f32_16x16x32_bf16 v[196:199], v[228:231], v[180:183], v[196:199]
    v_perm_b32 v236, v69, v65, s48
    v_perm_b32 v237, v77, v73, s48
    v_perm_b32 v238, v85, v81, s48
    v_perm_b32 v239, v93, v89, s48
    v_mfma_f32_16x16x32_bf16 v[200:203], v[232:235], v[180:183], v[200:203]
    buffer_load_dwordx4 v[124:127], v5, s[20:23], s49 offen offset:2304 nt
    v_perm_b32 v224, v70, v66, s47
    v_perm_b32 v225, v78, v74, s47
    v_perm_b32 v226, v86, v82, s47
    v_perm_b32 v227, v94, v90, s47
    v_mfma_f32_16x16x32_bf16 v[204:207], v[236:239], v[180:183], v[204:207]
    v_perm_b32 v228, v70, v66, s48
    v_perm_b32 v229, v78, v74, s48
    v_perm_b32 v230, v86, v82, s48
    v_perm_b32 v231, v94, v90, s48
    v_mfma_f32_16x16x32_bf16 v[208:211], v[224:227], v[180:183], v[208:211]
    v_perm_b32 v232, v71, v67, s47
    v_perm_b32 v233, v79, v75, s47
    v_perm_b32 v234, v87, v83, s47
    v_perm_b32 v235, v95, v91, s47
    v_mfma_f32_16x16x32_bf16 v[212:215], v[228:231], v[180:183], v[212:215]
    v_perm_b32 v236, v71, v67, s48
    v_perm_b32 v237, v79, v75, s48
    v_perm_b32 v238, v87, v83, s48
    v_perm_b32 v239, v95, v91, s48
    v_mfma_f32_16x16x32_bf16 v[216:219], v[232:235], v[180:183], v[216:219]
    s_nop 0
    v_mfma_f32_16x16x32_bf16 v[220:223], v[236:239], v[180:183], v[220:223]
L_pcheck:
    v_xor_b32 v8, s42, v174
    v_cmp_lt_u32 vcc, 3, v8
    s_cbranch_vccnz L_pretry
L_pok:
    v_and_b32 v174, 3, v174
    v_lshlrev_b32 v174, 12, v174
L_check_19:
    v_xor_b32 v16, s8, v16
    v_xor_b32 v17, s9, v17
    v_xor_b32 v18, s10, v18
    v_xor_b32 v19, s11, v19
    v_or_b32 v8, v16, v17
    v_or3_b32 v8, v8, v18, v19
    v_and_b32 v8, s0, v8
    v_cmp_ne_u32 vcc, 0, v8
    s_cbranch_vccnz L_retry_18
L_ok_20:
    v_mfma_f32_16x16x32_bf16 v[24:27], v[176:179], v[16:19], 0
    v_and_b32 v170, 15, v0
    v_lshlrev_b32 v170, 4, v170
    v_bfe_u32 v8, v0, 4, 1
    v_lshl_add_u32 v170, v8, 3, v170
    v_lshrrev_b32 v8, 6, v0
    v_lshl_add_u32 v170, v8, 8, v170
    v_lshrrev_b32 v9, 3, v0
    v_and_or_b32 v9, v9, 4, v170
    s_xor_b32 s49, s100, 0xc0000
    buffer_load_dwordx4 v[128:131], v5, s[20:23], s49 offen nt
    v_permlane32_swap_b32 v24, v26
    v_permlane32_swap_b32 v25, v27
    v_cvt_pk_bf16_f32 v24, v24, v26
    v_cvt_pk_bf16_f32 v25, v25, v27
    v_and_b32 v26, s62, v24
    v_lshlrev_b32 v24, 16, v24
    v_and_b32 v27, s62, v25
    v_lshlrev_b32 v25, 16, v25
    v_mul_f32 v24, v24, v26
    v_mul_f32 v25, v25, v27
    v_cvt_pk_bf16_f32 v24, v24, v25
    ds_write_b32 v9, v24 offset:35072
    s_lshl_b32 s59, s50, 10
    s_add_u32 s58, s59, 0x40000
    v_lshrrev_b32 v9, 5, v0
    v_lshlrev_b32 v9, 4, v9
    ds_read_b128 v[20:23], v9 offset:34816
    v_and_b32 v173, 7, v0
    v_lshl_add_u32 v173, v173, 7, s58
    v_add_u32 v173, v173, v9
    s_lshl2_add_u32 s58, s52, s57
    s_lshl3_add_u32 s58, s58, s55
    s_lshl_b32 s58, s58, 6
    v_and_b32 v172, 3, v0
    v_lshl_add_u32 v172, v172, 4, s58
    v_bfe_u32 v8, v0, 4, 1
    v_lshl_add_u32 v172, v8, 3, v172
    buffer_load_dwordx2 v[162:163], v172, s[4:7], 0 offen
    s_waitcnt vmcnt(7)
    buffer_load_dwordx4 v[132:135], v5, s[20:23], s49 offen offset:256 nt
    s_and_b32 s59, s50, 3
    s_lshl_b32 s59, s59, 17
    s_add_u32 s58, s59, 0x80000
    s_and_b32 s59, s52, 1
    s_lshl_b32 s59, s59, 10
    s_add_u32 s58, s58, s59
    s_bfe_u32 s59, s52, 0x20001
    s_lshl_b32 s59, s59, 14
    s_add_u32 s58, s58, s59
    s_lshl_b32 s59, s51, 7
    s_add_u32 s58, s58, s59
    v_and_b32 v164, 15, v0
    v_lshl_add_u32 v164, v164, 3, s58
    v_bfe_u32 v8, v0, 4, 3
    v_lshl_add_u32 v164, v8, 11, v164
    v_lshrrev_b32 v8, 7, v0
    v_lshl_add_u32 v164, v8, 16, v164
    v_xor_b32 v164, v174, v164
    v_and_b32 v166, 7, v0
    v_lshlrev_b32 v166, 4, v166
    v_bfe_u32 v8, v0, 4, 2
    v_lshl_add_u32 v166, v8, 7, v166
    v_lshrrev_b32 v8, 6, v0
    v_mul_u32_u24 v8, 4224, v8
    v_add_u32 v166, v166, v8
    v_and_b32 v165, 7, v0
    v_mul_u32_u24 v165, 528, v165
    v_bfe_u32 v8, v0, 3, 2
    v_lshl_add_u32 v165, v8, 7, v165
    v_lshrrev_b32 v8, 5, v0
    v_lshl_add_u32 v165, v8, 4, v165
    v_and_b32 v171, 1, v0
    v_lshlrev_b32 v171, 4, v171
    v_bfe_u32 v8, v0, 1, 3
    v_lshl_add_u32 v171, v8, 7, v171
    v_bfe_u32 v8, v0, 4, 2
    v_lshl_add_u32 v171, v8, 5, v171
    s_waitcnt vmcnt(7)
    buffer_load_dwordx4 v[136:139], v5, s[20:23], s49 offen offset:2048 nt
    s_waitcnt vmcnt(7)
    buffer_load_dwordx4 v[140:143], v5, s[20:23], s49 offen offset:2304 nt
    s_add_u32 s49, s49, 4096
    s_waitcnt vmcnt(7)
    buffer_load_dwordx4 v[144:147], v5, s[20:23], s49 offen nt
    buffer_load_dwordx4 v[240:243], v173, s[36:39], 0 offen sc1
    s_waitcnt vmcnt(8)
    buffer_load_dwordx4 v[148:151], v5, s[20:23], s49 offen offset:256 nt
    s_waitcnt vmcnt(8)
    buffer_load_dwordx4 v[152:155], v5, s[20:23], s49 offen offset:2048 nt
    v_perm_b32 v224, v100, v96, s47
    v_perm_b32 v225, v108, v104, s47
    v_perm_b32 v226, v116, v112, s47
    v_perm_b32 v227, v124, v120, s47
    v_perm_b32 v228, v100, v96, s48
    v_perm_b32 v229, v108, v104, s48
    v_perm_b32 v230, v116, v112, s48
    v_perm_b32 v231, v124, v120, s48
    v_mfma_f32_16x16x32_bf16 v[192:195], v[224:227], v[184:187], v[192:195]
    v_perm_b32 v232, v101, v97, s47
    v_perm_b32 v233, v109, v105, s47
    v_perm_b32 v234, v117, v113, s47
    v_perm_b32 v235, v125, v121, s47
    v_mfma_f32_16x16x32_bf16 v[196:199], v[228:231], v[184:187], v[196:199]
    v_perm_b32 v236, v101, v97, s48
    v_perm_b32 v237, v109, v105, s48
    v_perm_b32 v238, v117, v113, s48
    v_perm_b32 v239, v125, v121, s48
    v_mfma_f32_16x16x32_bf16 v[200:203], v[232:235], v[184:187], v[200:203]
    buffer_load_dwordx4 v[156:159], v5, s[20:23], s49 offen offset:2304 nt
    v_perm_b32 v224, v102, v98, s47
    v_perm_b32 v225, v110, v106, s47
    v_perm_b32 v226, v118, v114, s47
    v_perm_b32 v227, v126, v122, s47
    v_mfma_f32_16x16x32_bf16 v[204:207], v[236:239], v[184:187], v[204:207]
    v_perm_b32 v228, v102, v98, s48
    v_perm_b32 v229, v110, v106, s48
    v_perm_b32 v230, v118, v114, s48
    v_perm_b32 v231, v126, v122, s48
    v_mfma_f32_16x16x32_bf16 v[208:211], v[224:227], v[184:187], v[208:211]
    v_perm_b32 v232, v103, v99, s47
    v_perm_b32 v233, v111, v107, s47
    v_perm_b32 v234, v119, v115, s47
    v_perm_b32 v235, v127, v123, s47
    v_mfma_f32_16x16x32_bf16 v[212:215], v[228:231], v[184:187], v[212:215]
    v_perm_b32 v236, v103, v99, s48
    v_perm_b32 v237, v111, v107, s48
    v_perm_b32 v238, v119, v115, s48
    v_perm_b32 v239, v127, v123, s48
    v_mfma_f32_16x16x32_bf16 v[216:219], v[232:235], v[184:187], v[216:219]
    s_nop 0
    v_mfma_f32_16x16x32_bf16 v[220:223], v[236:239], v[184:187], v[220:223]
    s_lshl_b32 s59, s52, 11
    s_add_u32 s58, s59, 0x80000
    s_lshl_b32 s59, s55, 16
    s_add_u32 s58, s58, s59
    v_and_b32 v167, 7, v0
    v_lshl_add_u32 v167, v167, 4, s58
    v_bfe_u32 v8, v0, 3, 1
    v_lshl_add_u32 v167, v8, 10, v167
    v_bfe_u32 v8, v0, 4, 2
    v_lshl_add_u32 v167, v8, 7, v167
    v_lshrrev_b32 v8, 6, v0
    v_lshl_add_u32 v167, v8, 14, v167
    v_xor_b32 v167, v174, v167
    s_lshl_b32 s59, s57, 18
    s_add_u32 s58, s59, 0x100000
    s_and_b32 s59, s53, 15
    s_lshl_b32 s59, s59, 7
    s_add_u32 s58, s58, s59
    s_bfe_u32 s59, s53, 0x20004
    s_lshl_b32 s59, s59, 14
    s_add_u32 s58, s58, s59
    v_and_b32 v168, 7, v0
    v_lshl_add_u32 v168, v168, 4, s58
    v_bfe_u32 v8, v0, 3, 3
    v_lshl_add_u32 v168, v8, 11, v168
    v_lshrrev_b32 v8, 6, v0
    v_lshl_add_u32 v168, v8, 16, v168
    s_lshl_b32 s59, s57, 18
    s_add_u32 s58, s59, 0x100000
    s_and_b32 s59, s55, 1
    s_lshl_b32 s59, s59, 6
    s_add_u32 s58, s58, s59
    s_bfe_u32 s59, s55, 0x20001
    s_lshl_b32 s59, s59, 16
    s_add_u32 s58, s58, s59
    s_lshl_b32 s59, s52, 11
    s_add_u32 s58, s58, s59
    v_and_b32 v169, 3, v0
    v_lshl_add_u32 v169, v169, 4, s58
    v_bfe_u32 v8, v0, 2, 4
    v_lshl_add_u32 v169, v8, 7, v169
    v_xor_b32 v168, v174, v168
    v_xor_b32 v168, 0x1000, v168
    v_xor_b32 v169, v174, v169
    v_xor_b32 v169, 0x1000, v169
    s_mov_b32 s13, 16384
    s_mov_b32 s14, 32768
    s_mov_b32 s15, 49152
    s_mov_b32 s49, s101
    s_waitcnt vmcnt(4)
    buffer_load_dwordx4 v[32:35], v7, s[28:31], s49 offen nt
    v_perm_b32 v96, v132, v128, s47
    v_perm_b32 v100, v132, v128, s48
    v_perm_b32 v104, v133, v129, s47
    v_perm_b32 v108, v133, v129, s48
    v_perm_b32 v112, v134, v130, s47
    v_perm_b32 v116, v134, v130, s48
    v_perm_b32 v120, v135, v131, s47
    v_perm_b32 v124, v135, v131, s48
    v_perm_b32 v97, v140, v136, s47
    v_perm_b32 v101, v140, v136, s48
    v_perm_b32 v105, v141, v137, s47
    v_perm_b32 v109, v141, v137, s48
    v_perm_b32 v113, v142, v138, s47
    v_perm_b32 v117, v142, v138, s48
    v_perm_b32 v121, v143, v139, s47
    v_perm_b32 v125, v143, v139, s48
    s_waitcnt vmcnt(3)
    buffer_load_dwordx4 v[48:51], v7, s[28:31], s49 offen offset:2048 nt
L_check_22:
    v_xor_b32 v240, s43, v240
    v_xor_b32 v241, s44, v241
    v_xor_b32 v242, s45, v242
    v_xor_b32 v243, s46, v243
    v_or_b32 v8, v240, v241
    v_or3_b32 v8, v8, v242, v243
    v_and_b32 v8, 15, v8
    s_and_b32 s58, s42, -16
    v_xor_b32 v242, s58, v242
    v_xor_b32 v243, s58, v243
    v_or3_b32 v8, v8, v242, v243
    v_cmp_ne_u32 vcc, 0, v8
    s_cbranch_vccnz L_retry_21
L_ok_23:
    v_mov_b32 v8, v240
    s_waitcnt lgkmcnt(0)
    v_max3_f32 v161, v20, v21, v22
    v_max_f32 v161, v161, v23
    v_max_f32_dpp v8, v8, v8 quad_perm:[1,0,3,2] row_mask:0xf bank_mask:0xf
    s_nop 1
    v_max_f32_dpp v8, v8, v8 quad_perm:[2,3,0,1] row_mask:0xf bank_mask:0xf
    s_nop 1
    v_max_f32_dpp v8, v8, v8 row_half_mirror row_mask:0xf bank_mask:0xf
    v_sub_f32 v240, v240, v8
    v_sub_f32 v161, v161, v8
    v_mul_f32 v240, s64, v240
    v_mul_f32 v161, s64, v161
    v_exp_f32 v240, v240
    v_exp_f32 v161, v161
    v_mul_f32 v9, v240, v241
    s_nop 1
    v_add_f32_dpp v9, v9, v9 quad_perm:[1,0,3,2] row_mask:0xf bank_mask:0xf
    s_nop 1
    v_add_f32_dpp v9, v9, v9 quad_perm:[2,3,0,1] row_mask:0xf bank_mask:0xf
    s_nop 1
    v_add_f32_dpp v9, v9, v9 row_half_mirror row_mask:0xf bank_mask:0xf
    v_rcp_f32 v9, v9
    s_nop 0
    v_mul_f32 v161, v161, v9
    v_perm_b32 v98, v148, v144, s47
    v_perm_b32 v102, v148, v144, s48
    v_perm_b32 v106, v149, v145, s47
    v_perm_b32 v110, v149, v145, s48
    v_perm_b32 v114, v150, v146, s47
    v_perm_b32 v118, v150, v146, s48
    v_perm_b32 v122, v151, v147, s47
    v_perm_b32 v126, v151, v147, s48
    s_add_u32 s49, s49, 16384
    s_waitcnt vmcnt(3)
    buffer_load_dwordx4 v[36:39], v7, s[28:31], s49 offen nt
    s_waitcnt vmcnt(3)
    buffer_load_dwordx4 v[52:55], v7, s[28:31], s49 offen offset:2048 nt
    v_perm_b32 v99, v156, v152, s47
    v_perm_b32 v103, v156, v152, s48
    v_perm_b32 v107, v157, v153, s47
    v_mfma_f32_16x16x32_bf16 v[192:195], v[96:99], v[188:191], v[192:195]
    v_perm_b32 v111, v157, v153, s48
    v_mfma_f32_16x16x32_bf16 v[196:199], v[100:103], v[188:191], v[196:199]
    v_perm_b32 v115, v158, v154, s47
    v_mfma_f32_16x16x32_bf16 v[200:203], v[104:107], v[188:191], v[200:203]
    v_perm_b32 v119, v158, v154, s48
    v_mfma_f32_16x16x32_bf16 v[204:207], v[108:111], v[188:191], v[204:207]
    v_perm_b32 v123, v159, v155, s47
    v_mfma_f32_16x16x32_bf16 v[208:211], v[112:115], v[188:191], v[208:211]
    v_perm_b32 v127, v159, v155, s48
    v_mfma_f32_16x16x32_bf16 v[212:215], v[116:119], v[188:191], v[212:215]
    v_mfma_f32_16x16x32_bf16 v[216:219], v[120:123], v[188:191], v[216:219]
    v_mfma_f32_16x16x32_bf16 v[220:223], v[124:127], v[188:191], v[220:223]
    s_mov_b32 exec_lo, 0x00ff00ff
    s_mov_b32 exec_hi, 0x00ff00ff
    ds_write_b128 v166, v[192:195] offset:37120
    ds_write_b128 v166, v[196:199] offset:37648
    ds_write_b128 v166, v[200:203] offset:38176
    ds_write_b128 v166, v[204:207] offset:38704
    ds_write_b128 v166, v[208:211] offset:39232
    ds_write_b128 v166, v[212:215] offset:39760
    ds_write_b128 v166, v[216:219] offset:40288
    ds_write_b128 v166, v[220:223] offset:40816
    s_mov_b64 exec, -1
    s_waitcnt lgkmcnt(0)
    s_barrier
    ds_read_b128 v[224:227], v165 offset:37120
    ds_read_b128 v[228:231], v165 offset:41344
    ds_read_b128 v[232:235], v165 offset:45568
    ds_read_b128 v[236:239], v165 offset:49792
    ds_read_b128 v[16:19], v171 offset:35072
    s_waitcnt lgkmcnt(3)
    v_pk_add_f32 v[224:225], v[224:225], v[228:229]
    v_pk_add_f32 v[226:227], v[226:227], v[230:231]
    s_waitcnt lgkmcnt(1)
    v_pk_add_f32 v[232:233], v[232:233], v[236:237]
    v_pk_add_f32 v[234:235], v[234:235], v[238:239]
    v_pk_add_f32 v[224:225], v[224:225], v[232:233]
    v_pk_add_f32 v[226:227], v[226:227], v[234:235]
    v_mul_f32 v224, v224, v161
    v_mul_f32 v225, v225, v161
    v_mul_f32 v226, v226, v161
    v_mul_f32 v227, v227, v161
    v_add_u32 v224, s1, v224
    v_add_u32 v225, s1, v225
    v_add_u32 v226, s1, v226
    v_add_u32 v227, s1, v227
    v_perm_b32 v224, v225, v224, s48
    v_perm_b32 v225, v227, v226, s48
    s_nop 0
    v_mov_b32_dpp v226, v224 quad_perm:[1,1,3,3] row_mask:0xf bank_mask:0xf
    v_mov_b32_dpp v227, v225 quad_perm:[1,1,3,3] row_mask:0xf bank_mask:0xf
    v_bfi_b32 v224, v160, s8, v224
    v_bfi_b32 v225, v160, s9, v225
    v_bfi_b32 v226, v160, s10, v226
    v_bfi_b32 v227, v160, s11, v227
    s_mov_b32 exec_lo, 0x55555555
    s_mov_b32 exec_hi, 0x55555555
    buffer_store_dwordx4 v[224:227], v164, s[36:39], 0 offen sc1
    s_mov_b64 exec, -1
    s_add_u32 s49, s49, 16384
    buffer_load_dwordx4 v[40:43], v7, s[28:31], s49 offen nt
    buffer_load_dwordx4 v[56:59], v7, s[28:31], s49 offen offset:2048 nt
    s_add_u32 s49, s49, 16384
    buffer_load_dwordx4 v[44:47], v7, s[28:31], s49 offen nt
    buffer_load_dwordx4 v[60:63], v7, s[28:31], s49 offen offset:2048 nt
    s_mov_b32 s49, s101
    s_waitcnt vmcnt(8)
    buffer_load_dwordx4 v[64:67], v6, s[24:27], s49 offen nt
    s_waitcnt vmcnt(8)
    buffer_load_dwordx4 v[68:71], v6, s[24:27], s49 offen offset:2048 nt
    s_add_u32 s49, s49, 4096
    s_waitcnt vmcnt(8)
    buffer_load_dwordx4 v[72:75], v6, s[24:27], s49 offen nt
    s_waitcnt vmcnt(8)
    buffer_load_dwordx4 v[76:79], v6, s[24:27], s49 offen offset:2048 nt
    s_add_u32 s49, s49, 4096
    s_waitcnt vmcnt(7)
    buffer_load_dwordx4 v[80:83], v6, s[24:27], s49 offen nt
    s_waitcnt vmcnt(7)
    buffer_load_dwordx4 v[84:87], v6, s[24:27], s49 offen offset:2048 nt
    s_add_u32 s49, s49, 4096
    s_waitcnt vmcnt(7)
    buffer_load_dwordx4 v[88:91], v6, s[24:27], s49 offen nt
    s_waitcnt vmcnt(7)
    buffer_load_dwordx4 v[92:95], v6, s[24:27], s49 offen offset:2048 nt
    s_waitcnt lgkmcnt(0)
    v_perm_b32 v96, v36, v32, s47
    v_perm_b32 v100, v36, v32, s48
    v_perm_b32 v104, v37, v33, s47
    v_perm_b32 v108, v37, v33, s48
    v_perm_b32 v112, v38, v34, s47
    v_perm_b32 v116, v38, v34, s48
    v_perm_b32 v120, v39, v35, s47
    v_perm_b32 v124, v39, v35, s48
    v_perm_b32 v97, v44, v40, s47
    v_perm_b32 v101, v44, v40, s48
    v_perm_b32 v105, v45, v41, s47
    v_perm_b32 v109, v45, v41, s48
    v_perm_b32 v113, v46, v42, s47
    v_perm_b32 v117, v46, v42, s48
    v_perm_b32 v121, v47, v43, s47
    v_perm_b32 v125, v47, v43, s48
    v_perm_b32 v98, v52, v48, s47
    v_perm_b32 v102, v52, v48, s48
    v_perm_b32 v106, v53, v49, s47
    v_perm_b32 v110, v53, v49, s48
    v_perm_b32 v114, v54, v50, s47
    v_perm_b32 v118, v54, v50, s48
    v_perm_b32 v122, v55, v51, s47
    v_perm_b32 v126, v55, v51, s48
    v_perm_b32 v99, v60, v56, s47
    v_perm_b32 v103, v60, v56, s48
    v_perm_b32 v107, v61, v57, s47
    v_perm_b32 v111, v61, v57, s48
    v_perm_b32 v115, v62, v58, s47
    v_perm_b32 v119, v62, v58, s48
    v_perm_b32 v123, v63, v59, s47
    v_perm_b32 v127, v63, v59, s48
    s_waitcnt vmcnt(7)
    s_waitcnt vmcnt(6)
    v_perm_b32 v128, v68, v64, s47
    v_perm_b32 v132, v68, v64, s48
    v_perm_b32 v136, v69, v65, s47
    v_perm_b32 v140, v69, v65, s48
    v_perm_b32 v144, v70, v66, s47
    v_perm_b32 v148, v70, v66, s48
    v_perm_b32 v152, v71, v67, s47
    v_perm_b32 v156, v71, v67, s48
    s_waitcnt vmcnt(5)
    s_waitcnt vmcnt(4)
    v_perm_b32 v129, v76, v72, s47
    v_perm_b32 v133, v76, v72, s48
    v_perm_b32 v137, v77, v73, s47
    v_perm_b32 v141, v77, v73, s48
    v_perm_b32 v145, v78, v74, s47
    v_perm_b32 v149, v78, v74, s48
    v_perm_b32 v153, v79, v75, s47
    v_perm_b32 v157, v79, v75, s48
L_otop:
    buffer_load_dwordx4 v[240:243], v167, s[36:39], 0 offen offset:0 sc1
    buffer_load_dwordx4 v[244:247], v167, s[36:39], 0 offen offset:512 sc1
    s_waitcnt vmcnt(5)
    s_waitcnt vmcnt(4)
    v_perm_b32 v130, v84, v80, s47
    v_perm_b32 v134, v84, v80, s48
    v_perm_b32 v138, v85, v81, s47
    v_perm_b32 v142, v85, v81, s48
    v_perm_b32 v146, v86, v82, s47
    v_perm_b32 v150, v86, v82, s48
    v_perm_b32 v154, v87, v83, s47
    v_perm_b32 v158, v87, v83, s48
    s_waitcnt vmcnt(0)
L_check_25:
    v_xor_b32 v240, s8, v240
    v_xor_b32 v241, s9, v241
    v_xor_b32 v242, s10, v242
    v_xor_b32 v243, s11, v243
    v_xor_b32 v244, s8, v244
    v_xor_b32 v245, s9, v245
    v_mfma_f32_16x16x32_bf16 v[20:23], v[28:31], v[240:243], 0
    v_xor_b32 v246, s10, v246
    v_xor_b32 v247, s11, v247
    v_or_b32 v8, v240, v241
    v_or3_b32 v8, v8, v242, v243
    v_mfma_f32_16x16x32_bf16 v[20:23], v[28:31], v[244:247], v[20:23]
    v_or3_b32 v8, v8, v244, v245
    v_or3_b32 v8, v8, v246, v247
    v_and_b32 v8, s0, v8
    v_cmp_ne_u32 vcc, 0, v8
    s_cbranch_vccnz L_retry_24
L_ok_26:
    v_perm_b32 v131, v92, v88, s47
    v_perm_b32 v135, v92, v88, s48
    v_perm_b32 v139, v93, v89, s47
    v_cvt_pk_bf16_f32 v20, v20, v21
    v_cvt_pk_bf16_f32 v21, v22, v23
    ds_write_b64 v170, v[20:21] offset:36096
    v_mfma_f32_16x16x32_bf16 v[192:195], v[16:19], v[128:131], 0
    v_perm_b32 v143, v93, v89, s48
    v_perm_b32 v147, v94, v90, s47
    v_mfma_f32_16x16x32_bf16 v[196:199], v[16:19], v[132:135], 0
    v_perm_b32 v151, v94, v90, s48
    v_perm_b32 v155, v95, v91, s47
    v_mfma_f32_16x16x32_bf16 v[200:203], v[16:19], v[136:139], 0
    v_perm_b32 v159, v95, v91, s48
    s_waitcnt lgkmcnt(0)
    s_barrier
    ds_read_b128 v[24:27], v171 offset:36096
    v_mfma_f32_16x16x32_bf16 v[204:207], v[16:19], v[140:143], 0
    v_mfma_f32_16x16x32_bf16 v[208:211], v[16:19], v[144:147], 0
    v_mfma_f32_16x16x32_bf16 v[212:215], v[16:19], v[148:151], 0
    v_mfma_f32_16x16x32_bf16 v[216:219], v[16:19], v[152:155], 0
    v_mfma_f32_16x16x32_bf16 v[220:223], v[16:19], v[156:159], 0
    s_waitcnt lgkmcnt(0)
    v_mfma_f32_16x16x32_bf16 v[192:195], v[24:27], v[96:99], v[192:195]
    v_mfma_f32_16x16x32_bf16 v[196:199], v[24:27], v[100:103], v[196:199]
    v_mfma_f32_16x16x32_bf16 v[200:203], v[24:27], v[104:107], v[200:203]
    v_mfma_f32_16x16x32_bf16 v[204:207], v[24:27], v[108:111], v[204:207]
    s_nop 4
    v_add_f32_dpp v224, v193, v192 row_ror:8 row_mask:0xf bank_mask:0x3
    v_mfma_f32_16x16x32_bf16 v[208:211], v[24:27], v[112:115], v[208:211]
    v_add_f32_dpp v225, v197, v196 row_ror:8 row_mask:0xf bank_mask:0x3
    v_add_f32_dpp v224, v194, v195 row_ror:8 row_mask:0xf bank_mask:0xc
    v_add_u32 v224, s1, v224
    v_mfma_f32_16x16x32_bf16 v[212:215], v[24:27], v[116:119], v[212:215]
    v_add_f32_dpp v226, v201, v200 row_ror:8 row_mask:0xf bank_mask:0x3
    v_add_f32_dpp v225, v198, v199 row_ror:8 row_mask:0xf bank_mask:0xc
    v_add_u32 v225, s1, v225
    v_mfma_f32_16x16x32_bf16 v[216:219], v[24:27], v[120:123], v[216:219]
    v_add_f32_dpp v227, v205, v204 row_ror:8 row_mask:0xf bank_mask:0x3
    v_add_f32_dpp v226, v202, v203 row_ror:8 row_mask:0xf bank_mask:0xc
    v_perm_b32 v232, v225, v224, s48
    v_mfma_f32_16x16x32_bf16 v[220:223], v[24:27], v[124:127], v[220:223]
    v_add_f32_dpp v228, v209, v208 row_ror:8 row_mask:0xf bank_mask:0x3
    v_add_f32_dpp v227, v206, v207 row_ror:8 row_mask:0xf bank_mask:0xc
    v_add_u32 v226, s1, v226
    v_add_f32_dpp v229, v213, v212 row_ror:8 row_mask:0xf bank_mask:0x3
    v_add_f32_dpp v228, v210, v211 row_ror:8 row_mask:0xf bank_mask:0xc
    v_add_u32 v227, s1, v227
    v_add_f32_dpp v230, v217, v216 row_ror:8 row_mask:0xf bank_mask:0x3
    v_add_f32_dpp v229, v214, v215 row_ror:8 row_mask:0xf bank_mask:0xc
    v_bfi_b32 v232, v160, s8, v232
    v_add_f32_dpp v231, v221, v220 row_ror:8 row_mask:0xf bank_mask:0x3
    v_add_f32_dpp v230, v218, v219 row_ror:8 row_mask:0xf bank_mask:0xc
    v_perm_b32 v233, v227, v226, s48
    v_add_u32 v228, s1, v228
    v_add_f32_dpp v231, v222, v223 row_ror:8 row_mask:0xf bank_mask:0xc
    v_add_u32 v229, s1, v229
    v_add_u32 v230, s1, v230
    v_add_u32 v231, s1, v231
    v_bfi_b32 v233, v160, s9, v233
    v_perm_b32 v234, v229, v228, s48
    v_perm_b32 v235, v231, v230, s48
    v_bfi_b32 v234, v160, s10, v234
    v_bfi_b32 v235, v160, s11, v235
    buffer_store_dwordx4 v[232:235], v168, s[36:39], 0 offen sc1
    s_cmp_ge_u32 s3, 1
    s_cbranch_scc1 L_tail
    v_lshlrev_b32 v16, 16, v162
    v_and_b32 v17, s62, v162
    v_lshlrev_b32 v18, 16, v163
    v_and_b32 v19, s62, v163
    v_and_b32 v11, 1, v0
    v_lshlrev_b32 v10, 4, v11
    v_lshrrev_b32 v10, v10, s42
    v_mul_u32_u24 v11, 0x280000, v11
    s_waitcnt vmcnt(0)
L_ftop:
    buffer_load_dwordx4 v[240:243], v169, s[36:39], 0 offen sc1
    buffer_load_dwordx4 v[244:247], v169, s[36:39], s13 offen sc1
    buffer_load_dwordx4 v[248:251], v169, s[36:39], s14 offen sc1
    buffer_load_dwordx4 v[252:255], v169, s[36:39], s15 offen sc1
    s_add_u32 s60, s60, 1
    s_cmp_ge_u32 s60, 200000
    s_waitcnt vmcnt(0)
L_check_28:
    v_xor_b32 v240, s8, v240
    v_xor_b32 v241, s9, v241
    v_xor_b32 v242, s10, v242
    v_xor_b32 v243, s11, v243
    v_xor_b32 v244, s8, v244
    v_xor_b32 v245, s9, v245
    v_mfma_f32_16x16x32_bf16 v[20:23], v[28:31], v[240:243], 0
    v_xor_b32 v246, s10, v246
    v_xor_b32 v247, s11, v247
    v_xor_b32 v248, s8, v248
    v_xor_b32 v249, s9, v249
    v_mfma_f32_16x16x32_bf16 v[20:23], v[28:31], v[244:247], v[20:23]
    v_xor_b32 v250, s10, v250
    v_xor_b32 v251, s11, v251
    v_xor_b32 v252, s8, v252
    v_xor_b32 v253, s9, v253
    v_mfma_f32_16x16x32_bf16 v[20:23], v[28:31], v[248:251], v[20:23]
    v_xor_b32 v254, s10, v254
    v_xor_b32 v255, s11, v255
    v_or_b32 v8, v240, v241
    v_or3_b32 v8, v8, v242, v243
    v_mfma_f32_16x16x32_bf16 v[20:23], v[28:31], v[252:255], v[20:23]
    v_or3_b32 v8, v8, v244, v245
    v_or3_b32 v8, v8, v246, v247
    v_or3_b32 v8, v8, v248, v249
    v_or3_b32 v8, v8, v250, v251
    v_or3_b32 v8, v8, v252, v253
    v_or3_b32 v8, v8, v254, v255
    v_and_b32 v8, s0, v8
    v_cmp_ne_u32 vcc, 0, v8
    s_cbranch_scc1 L_ok_29
    s_cbranch_vccnz L_ftop
L_ok_29:
    v_add_f32_dpp v20, v20, v20 row_ror:8 row_mask:0xf bank_mask:0xf
    v_add_f32_dpp v21, v21, v21 row_ror:8 row_mask:0xf bank_mask:0xf
    v_add_f32_dpp v22, v22, v22 row_ror:8 row_mask:0xf bank_mask:0xf
    v_add_f32_dpp v23, v23, v23 row_ror:8 row_mask:0xf bank_mask:0xf
    v_add_f32_dpp v20, v20, v20 row_ror:4 row_mask:0xf bank_mask:0xf
    v_add_f32_dpp v21, v21, v21 row_ror:4 row_mask:0xf bank_mask:0xf
    v_add_f32_dpp v22, v22, v22 row_ror:4 row_mask:0xf bank_mask:0xf
    v_add_f32_dpp v23, v23, v23 row_ror:4 row_mask:0xf bank_mask:0xf
    v_pk_add_f32 v[20:21], v[20:21], v[16:17]
    v_pk_add_f32 v[22:23], v[22:23], v[18:19]
    v_cvt_pk_bf16_f32 v20, v20, v21
    v_cvt_pk_bf16_f32 v21, v22, v23
    s_mov_b64 exec, 0x000f000f
    buffer_store_dwordx2 v[20:21], v172, s[32:35], 0 offen sc1
    s_cmp_lg_u32 s2, 0
    s_cbranch_scc1 L_tail
    s_mov_b64 exec, 3
    buffer_store_dword v10, v11, s[36:39], 0 offen offset:0 sc1
L_tail:
L_done:
    s_endpgm
L_probe:
    s_mul_i32 s58, s3, 0x900
    s_add_u32 s58, s58, 0x4000
    s_xor_b32 s59, s58, 0x2000
    s_mov_b32 s96, 0
    s_waitcnt lgkmcnt(0)
    s_load_dword s94, s[36:37], s58 glc
    s_load_dwordx2 s[90:91], s[36:37], s59 glc
    s_waitcnt lgkmcnt(2)
    s_getreg_b32 s92, hwreg(HW_REG_IB_STS, 8, 4)
    s_cmp_eq_u32 s92, 2
    s_addc_u32 s96, s96, 0
    s_cmp_eq_u32 s92, 1
    s_subb_u32 s96, s96, 0
    s_waitcnt lgkmcnt(0)
    s_load_dword s94, s[36:37], s59 glc
    s_load_dwordx2 s[90:91], s[36:37], s58 glc
    s_waitcnt lgkmcnt(2)
    s_getreg_b32 s92, hwreg(HW_REG_IB_STS, 8, 4)
    s_cmp_eq_u32 s92, 1
    s_addc_u32 s96, s96, 0
    s_cmp_eq_u32 s92, 2
    s_subb_u32 s96, s96, 0
    s_waitcnt lgkmcnt(0)
    s_mov_b32 s59, s96
    s_lshl_b32 s58, s3, 2
    v_mov_b32 v10, s58
    v_mov_b32 v11, s59
    ds_write_b32 v10, v11 offset:54016
    s_branch L_probe_back
L_par:
    v_mov_b32 v249, 0
    ds_read_b128 v[240:243], v249 offset:54016
    s_and_b32 s61, s42, -4
    s_waitcnt lgkmcnt(0)
    v_add3_u32 v240, v240, v241, v242
    v_add_u32 v240, v240, v243
    v_lshrrev_b32 v240, 30, v240
    v_and_or_b32 v240, v240, 2, s61
    s_cmp_lg_u32 s3, 0
    s_cbranch_scc1 L_par_back
    s_mov_b64 exec, 1
    buffer_store_dword v240, v249, s[36:39], 0 offen offset:128 sc1
    s_mov_b64 exec, -1
    s_branch L_par_back
L_retry_15:
    s_cmp_ge_u32 s60, 200000
    s_cbranch_scc1 L_ok_17
    buffer_load_dwordx4 v[240:243], v14, s[36:39], 0 offen sc1
    buffer_load_dwordx4 v[244:247], v14, s[36:39], s41 offen sc1
    buffer_load_dwordx4 v[248:251], v15, s[36:39], 0 offen sc1
    buffer_load_dwordx4 v[252:255], v15, s[36:39], s41 offen sc1
    s_add_u32 s60, s60, 1
    s_waitcnt vmcnt(0)
    s_branch L_check_16
L_pretry:
    s_cmp_ge_u32 s60, 200000
    s_cbranch_scc1 L_pok
    buffer_load_dword v174, v175, s[36:39], 0 offen offset:128 sc1
    s_add_u32 s60, s60, 1
    s_waitcnt vmcnt(0)
    s_branch L_pcheck
L_retry_18:
    s_cmpk_ge_u32 s2, 224
    s_cbranch_scc1 L_ok_20
    s_cmp_ge_u32 s60, 200000
    s_cbranch_scc1 L_ok_20
    buffer_load_dwordx4 v[16:19], v14, s[36:39], 0 offen sc1
    s_add_u32 s60, s60, 1
    s_waitcnt vmcnt(0)
    s_branch L_check_19
L_retry_21:
    s_cmp_ge_u32 s60, 200000
    s_cbranch_scc1 L_ok_23
    buffer_load_dwordx4 v[240:243], v173, s[36:39], 0 offen sc1
    s_add_u32 s60, s60, 1
    s_waitcnt vmcnt(0)
    s_branch L_check_22
L_retry_24:
    s_cmp_ge_u32 s60, 200000
    s_cbranch_scc1 L_ok_26
    buffer_load_dwordx4 v[240:243], v167, s[36:39], 0 offen offset:0 sc1
    buffer_load_dwordx4 v[244:247], v167, s[36:39], 0 offen offset:512 sc1
    s_add_u32 s60, s60, 1
    s_waitcnt vmcnt(0)
    s_branch L_check_25
L_end:
.section .rodata,"a"
.p2align 6
.amdhsa_kernel parallel_sum__gqa_block_cached__glu_gated_bilinear__decode_kernel
  .amdhsa_next_free_vgpr 384
  .amdhsa_next_free_sgpr 102
  .amdhsa_accum_offset 256
  .amdhsa_group_segment_fixed_size 0
  .amdhsa_kernarg_size 96
  .amdhsa_user_sgpr_count 2
  .amdhsa_user_sgpr_kernarg_segment_ptr 1
  .amdhsa_system_sgpr_workgroup_id_x 1
  .amdhsa_float_denorm_mode_32 3
.end_amdhsa_kernel
```
